```python
import torch

def _softmax(x, axis=-1):
    return torch.softmax(x, dim=axis)

def _gelu(x):
    return torch.nn.functional.gelu(x, approximate='tanh')

def _silu(x):
    return torch.nn.functional.silu(x)

def _sigmoid(x):
    return torch.sigmoid(x)

def _layernorm(x, axis=-1, eps=1e-05):
    m = x.mean(dim=axis, keepdim=True)
    v = x.var(dim=axis, keepdim=True, unbiased=False)
    return (x - m) / torch.sqrt(v + eps)

def _scatter_add(tgt, idx, src, axis=0):
    return tgt.clone().index_add_(axis, idx, src)

def _segment_sum(src, seg, n):
    out = torch.zeros((n,) + src.shape[1:], dtype=src.dtype)
    return out.index_add_(0, seg, src)

def _pad(x, pw):
    flat = tuple((v for pair in reversed(pw) for v in pair))
    return torch.nn.functional.pad(x, flat)
kernel_name = 'adaLN_cond__ssm_conv_s4__dense_activation_silu__prompt'

def setup_inputs():

    _w = lambda a: (lambda t: t.to(torch.bfloat16) if t.is_floating_point() else t)(torch.as_tensor(a))

    def _A_setup():
        B, L, D, N = (1, 2048, 640, 192)
        A_re = -(lambda _x: torch.exp(torch.as_tensor(_x)))((lambda *s: torch.randn(*s, dtype=torch.bfloat16) * 3.2)(D, N))
        A_im = torch.pi * (lambda *s: torch.randn(*s, dtype=torch.bfloat16) * 0.05)(D, N)
        B_re = (lambda *s: torch.randn(*s, dtype=torch.bfloat16) * 0.1)(D, N)
        B_im = (lambda *s: torch.randn(*s, dtype=torch.bfloat16) * 0.1)(D, N)
        C_re = (lambda *s: torch.randn(*s, dtype=torch.bfloat16) * 0.1)(D, N)
        C_im = (lambda *s: torch.randn(*s, dtype=torch.bfloat16) * 0.1)(D, N)
        log_dt = (lambda *s: torch.randn(*s, dtype=torch.bfloat16) * 0.05)(D) * 0.5 - 4.0
        Dskip = (lambda *s: torch.randn(*s, dtype=torch.bfloat16) * 0.05)(D)
        return {'u': _w((lambda *s: torch.randn(*s, dtype=torch.bfloat16) * 0.05)(B, L, D)), 'A_re': _w(A_re), 'A_im': _w(A_im), 'B_re': _w(B_re), 'B_im': _w(B_im), 'C_re': _w(C_re), 'C_im': _w(C_im), 'log_dt': _w(log_dt), 'Dskip': _w(Dskip)}
    _A_in = _A_setup()

    def _B_setup():
        B, S, D, F = (1, 2048, 640, 1536)
        return {'x': _w((lambda *s: torch.randn(*s, dtype=torch.bfloat16) * 0.05)(B, S, D)), 'w1': _w((lambda *s: torch.randn(*s, dtype=torch.bfloat16) * 3.2)(D, F) * D ** (-0.5)), 'w2': _w((lambda *s: torch.randn(*s, dtype=torch.bfloat16) * 0.2)(F, D) * F ** (-0.5))}
    _B_in = _B_setup()
    return {'A_u': _A_in['u'], 'A_A_re': _A_in['A_re'], 'A_A_im': _A_in['A_im'], 'A_B_re': _A_in['B_re'], 'A_B_im': _A_in['B_im'], 'A_C_re': _A_in['C_re'], 'A_C_im': _A_in['C_im'], 'A_log_dt': _A_in['log_dt'], 'A_Dskip': _A_in['Dskip'], 'B_x': _B_in['x'], 'B_w1': _B_in['w1'], 'B_w2': _B_in['w2'], 'c': _w((lambda *s: torch.randn(*s, dtype=torch.bfloat16) * 0.2)(1, 640) * 8.0), 'w_mod': _w((lambda *s: torch.randn(*s, dtype=torch.bfloat16) * 0.2)(640, 6 * 640) * 640 ** (-0.5) * 8.0)}

def reference(A_u, A_A_re, A_A_im, A_B_re, A_B_im, A_C_re, A_C_im, A_log_dt, A_Dskip, B_x, B_w1, B_w2, c, w_mod):

    def _A_ref(u, A_re, A_im, B_re, B_im, C_re, C_im, log_dt, Dskip):
        Bsz, L, D = u.shape
        dt = torch.exp(log_dt)[:, None]
        A = A_re + 1j * A_im
        Bc = B_re + 1j * B_im
        Cc = C_re + 1j * C_im
        logdA = dt * A
        dB = dt * Bc
        l = (lambda x, dt: x.to(dt))(torch.arange(L), A_re.dtype)
        P = torch.exp(logdA[:, :, None] * l[None, None, :])
        K = torch.einsum('dn,dnl,dn->dl', Cc, P, dB).real
        L2 = 2 * L
        Kp = _pad(K, ((0, 0), (0, L)))
        up = (lambda x, *d: x.permute(*d))(u, 0, 2, 1)
        up = _pad(up, ((0, 0), (0, 0), (0, L)))
        Kf = (lambda x, axes=(-2, -1): torch.fft.rfft2(x.float(), dim=axes))(Kp[:, None, :], axes=(-2, -1))
        Uf = (lambda x, axes=(-2, -1): torch.fft.rfft2(x.float(), dim=axes))(up[:, :, None, :], axes=(-2, -1))
        Yf = Uf * Kf[None, :, :, :]
        y = (lambda x, s, axes=(-2, -1): torch.fft.irfft2(x, s=s, dim=axes).to(torch.bfloat16))(Yf, (1, L2), axes=(-2, -1))[:, :, 0, :L]
        y = (lambda x, *d: x.permute(*d))(y, 0, 2, 1) + u * Dskip[None, None, :]
        return y

    def _B_ref(x, w1, w2):
        h = torch.einsum('bsd,df->bsf', x, w1)
        h = _silu(h)
        out = torch.einsum('bsf,fd->bsd', h, w2)
        return out
    x = A_u
    mod = (_silu(c) @ w_mod).reshape(c.shape[0], 6, 1, -1)
    sa, ca, ga, sb, cb, gb = (mod[:, 0].clone(), mod[:, 1].clone(), mod[:, 2].clone(), mod[:, 3].clone(), mod[:, 4].clone(), mod[:, 5].clone())
    h = _layernorm(x, axis=-1) * (1 + ca) + sa
    x = x + ga * _A_ref(h, A_A_re, A_A_im, A_B_re, A_B_im, A_C_re, A_C_im, A_log_dt, A_Dskip)
    h = _layernorm(x, axis=-1) * (1 + cb) + sb
    x = x + gb * _B_ref(h, B_w1, B_w2)
    return x
```

```asm
; @launch grid=(256,1,1) block=(256,1,1) lds=149760
.amdgcn_target "amdgcn-amd-amdhsa--gfx950"
.text
.globl adaLN_cond__ssm_conv_s4__dense_activation_silu__prompt_kernel
.p2align 8
.type adaLN_cond__ssm_conv_s4__dense_activation_silu__prompt_kernel,@function
adaLN_cond__ssm_conv_s4__dense_activation_silu__prompt_kernel:
    s_cmp_ge_u32 s2, 256
    s_cbranch_scc1 LF_end
    s_load_dwordx16 s[36:51], s[0:1], 0
    s_load_dwordx2 s[52:53], s[0:1], 64
    s_load_dwordx4 s[60:63], s[0:1], 96
    s_load_dwordx2 s[68:69], s[0:1], 128
    s_load_dwordx4 s[56:59], s[0:1], 80
    s_load_dwordx4 s[64:67], s[0:1], 112
    v_lshrrev_b32 v1, 6, v0
    s_nop 0
    v_readfirstlane_b32 s21, v1
    v_and_b32 v1, 63, v0
    s_getpc_b64 s[24:25]
LF_pc:
    s_lshr_b32 s26, s2, 3
    s_lshl_b32 s26, s26, 2
    s_add_u32 s26, s26, s21
    s_mul_i32 s26, s26, 384
    s_min_u32 s26, s26, LF_codeend-LF_pc-384
    s_add_u32 s24, s24, s26
    s_addc_u32 s25, s25, 0
    v_min_u32 v2, 2, v1
    v_lshlrev_b32 v2, 7, v2
    v_mov_b32 v3, s25
    v_add_co_u32 v2, vcc, s24, v2
    s_nop 1
    v_addc_co_u32 v3, vcc, 0, v3, vcc
    global_load_dword v254, v[2:3], off
    v_lshlrev_b32 v8, 4, v1
    s_cmp_lt_u32 s2, 160
    s_cbranch_scc0 LF_side
    s_lshl_b32 s20, s2, 2
    s_add_u32 s20, s20, s21
    s_mul_i32 s29, s20, 384
    v_lshl_add_u32 v10, v1, 1, s29
    s_lshl_b32 s29, s20, 1
    v_mov_b32 v11, s29
    v_mov_b32 v123, 0
    v_mov_b32 v134, 0
    v_mov_b32 v135, 0
    v_mov_b32 v136, 0
    v_mov_b32 v137, 0
    v_mov_b32 v138, 0
    v_mov_b32 v139, 0
    v_mov_b32 v140, 0
    v_mov_b32 v141, 0
    v_mov_b32 v142, 0
    v_mov_b32 v143, 0
    v_mov_b32 v144, 0
    v_mov_b32 v145, 0
    v_mov_b32 v146, 0
    v_mov_b32 v147, 0
    v_mov_b32 v148, 0
    v_mov_b32 v149, 0
    v_mov_b32 v150, 0
    v_mov_b32 v151, 0
    v_mov_b32 v152, 0
    v_mov_b32 v154, 0
    s_mul_hi_u32 s25, s2, 107374183
    s_mul_i32 s26, s25, 40
    s_sub_u32 s26, s2, s26
    s_cmp_ge_u32 s26, 30
    s_cselect_b32 s27, 20, 0
    s_add_u32 s26, s26, s27
    s_mul_i32 s27, s25, 320
    v_lshl_add_u32 v6, v1, 2, s27
    v_and_b32 v7, 15, v1
    v_lshl_add_u32 v7, v7, 2, s27
    s_waitcnt lgkmcnt(0)
    global_load_dword v156, v6, s[60:61]
    global_load_dword v157, v7, s[60:61] offset:256
    global_load_short_d16_hi v152, v11, s[50:51]
    global_load_short_d16_hi v134, v10, s[38:39] offset:0
    global_load_short_d16_hi v135, v10, s[40:41] offset:0
    global_load_short_d16_hi v136, v10, s[42:43] offset:0
    global_load_short_d16_hi v137, v10, s[44:45] offset:0
    global_load_short_d16_hi v138, v10, s[46:47] offset:0
    global_load_short_d16_hi v139, v10, s[48:49] offset:0
    global_load_short_d16_hi v140, v10, s[38:39] offset:128
    global_load_short_d16_hi v141, v10, s[40:41] offset:128
    global_load_short_d16_hi v142, v10, s[42:43] offset:128
    global_load_short_d16_hi v143, v10, s[44:45] offset:128
    global_load_short_d16_hi v144, v10, s[46:47] offset:128
    global_load_short_d16_hi v145, v10, s[48:49] offset:128
    global_load_short_d16_hi v146, v10, s[38:39] offset:256
    global_load_short_d16_hi v147, v10, s[40:41] offset:256
    global_load_short_d16_hi v148, v10, s[42:43] offset:256
    global_load_short_d16_hi v149, v10, s[44:45] offset:256
    global_load_short_d16_hi v150, v10, s[46:47] offset:256
    global_load_short_d16_hi v151, v10, s[48:49] offset:256
    global_load_short_d16_hi v154, v11, s[52:53]
    v_bfe_u32 v11, v1, 2, 2
    v_lshrrev_b32 v12, 4, v1
    v_and_b32 v10, 3, v1
    v_and_b32 v13, 15, v1
    v_lshrrev_b32 v4, 3, v1
    v_and_b32 v5, 7, v1
    v_mul_u32_u24 v3, 7680, v4
    v_lshl_add_u32 v3, v5, 4, v3
    s_mul_i32 s27, s25, 160
    s_mul_i32 s28, s21, 40
    s_add_u32 s28, s28, s27
    s_mul_i32 s28, s28, 7680
    s_lshl_b32 s29, s26, 7
    s_add_u32 s28, s28, s29
    v_add_u32 v3, s28, v3
    s_mul_i32 s29, s21, 5120
    s_add_u32 m0, s29, 13312
    s_mul_i32 s25, s25, 15360
    v_mov_b32 v163, v3
    s_lshl_b32 s26, s26, 8
    s_add_u32 s25, s25, s26
    s_lshl_b32 s26, s21, 6
    s_add_u32 s25, s25, s26
    v_lshl_add_u32 v158, v1, 2, s25
    v_lshl_add_u32 v7, v12, 3, v11
    v_lshlrev_b32 v7, 7, v7
    v_lshl_add_u32 v7, v10, 3, v7
    s_lshl_b32 s27, s21, 5
    s_add_u32 s27, s27, 13312
    v_add_u32 v159, s27, v7
    s_mul_i32 s27, s21, 320
    v_lshl_add_u32 v160, v1, 2, s27
    v_lshl_add_u32 v161, v13, 2, s27
    v_lshl_add_u32 v162, v12, 4, s27
    s_mul_i32 s26, s21, 8448
    s_add_u32 s26, s26, 107520
    v_sub_u32 v14, 3, v11
    v_mul_u32_u24 v14, 2112, v14
    v_lshl_add_u32 v14, v10, 3, v14
    v_add_u32 v14, s26, v14
    v_lshlrev_b32 v15, 4, v12
    v_sub_u32 v15, 48, v15
    v_add_u32 v240, v14, v15
    v_and_b32 v15, 1, v12
    v_lshrrev_b32 v9, 1, v12
    v_lshlrev_b32 v16, 3, v15
    v_sub_u32 v14, v14, v16
    v_add_u32 v14, 8, v14
    v_mul_u32_u24 v16, 192, v9
    v_add_u32 v241, v14, v16
    v_mul_u32_u24 v16, 160, v9
    v_add_u32 v242, v14, v16
    s_mul_i32 s27, s21, 16016
    v_lshlrev_b32 v14, 5, v13
    v_add_u32 v14, s27, v14
    v_lshl_add_u32 v230, v12, 4, v14
    v_lshl_add_u32 v14, v9, 4, v14
    v_mul_u32_u24 v16, 3088, v15
    v_add_u32 v235, v14, v16
    v_lshlrev_b32 v14, 7, v15
    v_lshl_add_u32 v14, v11, 5, v14
    v_lshl_add_u32 v14, v10, 3, v14
    v_add_u32 v14, s27, v14
    v_mul_u32_u24 v16, 3072, v9
    v_sub_u32 v17, v14, v16
    v_add_u32 v231, 7664, v17
    v_add_u32 v17, v14, v16
    v_add_u32 v233, 10768, v17
    v_lshlrev_b32 v16, 5, v9
    v_sub_u32 v16, 16, v16
    v_add_u32 v232, v231, v16
    v_bfe_u32 v16, v1, 1, 2
    v_xor_b32 v16, s21, v16
    v_lshlrev_b32 v16, 4, v16
    v_lshl_add_u32 v16, v13, 7, v16
    v_lshl_add_u32 v16, v15, 6, v16
    v_add_u32 v234, 64064, v16
    v_mul_u32_u24 v16, 16016, v10
    v_lshrrev_b32 v14, 2, v1
    s_lshl_b32 s28, s21, 4
    v_add_u32 v14, s28, v14
    v_lshl_add_u32 v236, v14, 6, v16
    v_lshlrev_b32 v14, 8, v14
    v_lshl_add_u32 v14, v10, 4, v14
    s_lshl_b32 s29, s2, 14
    s_add_u32 s28, s29, 1048576
    v_add_u32 v237, s28, v14
    v_xor_b32 v14, v10, v12
    v_and_b32 v16, 0x3c, v1
    v_lshlrev_b32 v16, 4, v16
    v_lshl_add_u32 v14, v14, 4, v16
    s_lshl_b32 s28, s21, 12
    s_add_u32 s29, s29, s28
    s_add_u32 s29, s29, 1048576
    v_add_u32 v238, s29, v14
    s_add_u32 s29, s28, 262144
    v_add_u32 v253, s29, v8
    v_min_u32 v14, 2, v12
    v_mul_u32_u24 v14, 2560, v14
    v_mul_u32_u24 v16, 15360, v11
    v_add_u32 v14, v14, v16
    v_lshl_add_u32 v14, v10, 2, v14
    s_lshl_b32 s29, s2, 4
    v_add_u32 v239, s29, v14
    v_lshlrev_b32 v243, 2, v10
    v_add_u32 v252, 80448, v8
    v_lshlrev_b32 v14, 3, v12
    v_sub_u32 v14, v14, v13
    v_add_u32 v14, 15, v14
    v_and_b32 v16, 1, v14
    v_cmp_eq_u32 vcc, 1, v16
    v_lshrrev_b32 v14, 1, v14
    v_min_u32 v14, 15, v14
    v_lshl_or_b32 v14, v14, 16, v14
    v_mov_b32 v16, 8388608
    v_mov_b32 v17, 128
    v_cndmask_b32 v16, v16, v17, vcc
    v_pk_lshrrev_b16 v16, v14, v16
    v_and_b32 v17, 65537, v16
    v_mul_u32_u24 v210, 16256, v17
    v_and_b32 v17, 131074, v16
    v_mul_u32_u24 v211, 8128, v17
    v_and_b32 v17, 262148, v16
    v_mul_u32_u24 v212, 4064, v17
    v_and_b32 v17, 524296, v16
    v_mul_u32_u24 v213, 2032, v17
    v_mov_b32 v16, 536895488
    v_mov_b32 v17, 805314560
    v_cndmask_b32 v16, v16, v17, vcc
    v_pk_lshrrev_b16 v16, v14, v16
    v_and_b32 v17, 65537, v16
    v_mul_u32_u24 v214, 16256, v17
    v_and_b32 v17, 131074, v16
    v_mul_u32_u24 v215, 8128, v17
    v_and_b32 v17, 262148, v16
    v_mul_u32_u24 v216, 4064, v17
    v_and_b32 v17, 524296, v16
    v_mul_u32_u24 v217, 2032, v17
    v_mov_b32 v16, 469768192
    v_mov_b32 v17, 201333760
    v_cndmask_b32 v16, v16, v17, vcc
    v_pk_lshrrev_b16 v16, v14, v16
    v_and_b32 v17, 65537, v16
    v_mul_u32_u24 v218, 16256, v17
    v_and_b32 v17, 131074, v16
    v_mul_u32_u24 v219, 8128, v17
    v_and_b32 v17, 262148, v16
    v_mul_u32_u24 v220, 4064, v17
    v_and_b32 v17, 524296, v16
    v_mul_u32_u24 v221, 2032, v17
    v_mov_b32 v16, 469777408
    v_mov_b32 v17, 503323648
    v_cndmask_b32 v16, v16, v17, vcc
    v_pk_lshrrev_b16 v16, v14, v16
    v_and_b32 v17, 65537, v16
    v_mul_u32_u24 v222, 16256, v17
    v_and_b32 v17, 131074, v16
    v_mul_u32_u24 v223, 8128, v17
    v_and_b32 v17, 262148, v16
    v_mul_u32_u24 v224, 4064, v17
    v_and_b32 v17, 524296, v16
    v_mul_u32_u24 v225, 2032, v17
    v_mov_b32 v16, 1040202752
    v_mov_b32 v17, 503332352
    v_cndmask_b32 v16, v16, v17, vcc
    v_pk_lshrrev_b16 v16, v14, v16
    v_and_b32 v17, 65537, v16
    v_mul_u32_u24 v226, 16256, v17
    v_and_b32 v17, 131074, v16
    v_mul_u32_u24 v227, 8128, v17
    v_and_b32 v17, 262148, v16
    v_mul_u32_u24 v228, 4064, v17
    v_and_b32 v17, 524296, v16
    v_mul_u32_u24 v229, 2032, v17
    s_mul_i32 s26, s21, 18432
    s_add_u32 s26, s26, 33792
    v_mul_u32_u24 v14, 144, v1
    v_add_u32 v120, s26, v14
    v_lshrrev_b32 v15, 5, v1
    v_lshl_add_u32 v14, v11, 1, v15
    v_mul_u32_u24 v14, 288, v14
    v_bfe_u32 v16, v1, 4, 1
    v_lshl_add_u32 v14, v16, 5, v14
    v_lshl_add_u32 v14, v10, 3, v14
    v_add_u32 v121, s26, v14
    s_mul_i32 s26, s21, 2112
    s_add_u32 s26, s26, 141312
    v_mov_b32 v24, 0
    v_mov_b32 v25, 0
    v_mov_b32 v26, 0
    v_mov_b32 v27, 0
    v_add_u32 v132, s26, v8
    ds_write_b128 v132, v[24:27]
    ds_write_b128 v132, v[24:27] offset:1024
    v_mov_b32 v28, s26
    ds_write_b128 v28, v[24:27] offset:2048
    v_and_b32 v34, 1, v1
    v_bfe_u32 v35, v1, 1, 4
    v_or_b32 v36, v34, v15
    v_mul_u32_u24 v37, 48, v34
    v_mul_u32_u24 v38, 96, v15
    v_add3_u32 v36, v36, v37, v38
    v_add_u32 v36, v36, v35
    v_lshl_add_u32 v124, v36, 1, s26
    v_add_u32 v39, 2020, v28
    v_add_u32 v36, 1182, v124
    v_cmp_eq_u32 vcc, 0, v35
    v_mul_u32_u24 v37, 79, v34
    v_lshl_add_u32 v38, v15, 4, v35
    v_cndmask_b32 v125, v36, v39, vcc
    v_sub_u32 v38, v38, v37
    v_add_u32 v38, 863, v38
    v_lshl_add_u32 v126, v38, 1, s26
    v_add_u32 v37, 1126, v28
    v_cmp_eq_u32 vcc, 0, v1
    v_add_u32 v40, 1128, v28
    v_add_u32 v41, 1854, v28
    v_cndmask_b32 v127, v126, v37, vcc
    v_cndmask_b32 v128, v39, v40, vcc
    v_cndmask_b32 v129, v39, v41, vcc
    v_add_u32 v37, 1246, v28
    v_cmp_eq_u32 vcc, 32, v1
    v_and_b32 v38, 31, v1
    v_lshlrev_b32 v38, 4, v38
    v_cndmask_b32 v129, v129, v37, vcc
    v_lshl_add_u32 v38, v15, 3, v38
    v_add_u32 v130, s26, v38
    v_and_b32 v37, 30, v1
    v_cmp_eq_u32 vcc, 0, v37
    v_add_u32 v37, 976, v28
    s_nop 0
    v_cndmask_b32 v131, v37, v130, vcc
    v_mov_b32 v104, 0
    v_mov_b32 v105, 0
    v_mov_b32 v106, 0
    v_mov_b32 v107, 0
    v_mov_b32 v108, 0
    v_mov_b32 v109, 0
    v_mov_b32 v110, 0
    v_mov_b32 v111, 0
    v_mov_b32 v112, 0
    v_mov_b32 v113, 0
    v_mov_b32 v114, 0
    v_mov_b32 v115, 0
    v_mov_b32 v116, 0
    v_mov_b32 v117, 0
    v_mov_b32 v118, 0
    v_mov_b32 v119, 0
    s_mov_b32 s86, 1069066811
    s_mov_b32 s87, 1042479491
    s_mov_b32 s3, 0
    s_waitcnt vmcnt(20)
    s_mov_b32 s24, 3216550459
    v_lshlrev_b32 v16, 16, v156
    v_and_b32 v17, 0xffff0000, v156
    v_lshlrev_b32 v18, 16, v157
    v_and_b32 v19, 0xffff0000, v157
    v_mul_f32 v20, s24, v16
    v_mul_f32 v21, s24, v17
    v_mul_f32 v22, s24, v18
    v_mul_f32 v23, s24, v19
    v_exp_f32 v20, v20
    v_exp_f32 v21, v21
    v_exp_f32 v22, v22
    v_exp_f32 v23, v23
    v_add_f32 v20, 1.0, v20
    v_add_f32 v21, 1.0, v21
    v_add_f32 v22, 1.0, v22
    v_add_f32 v23, 1.0, v23
    v_rcp_f32 v20, v20
    v_rcp_f32 v21, v21
    v_rcp_f32 v22, v22
    v_rcp_f32 v23, v23
    v_mul_f32 v16, v16, v20
    v_mul_f32 v17, v17, v21
    v_mul_f32 v18, v18, v22
    v_mul_f32 v19, v19, v23
    v_cvt_pk_bf16_f32 v16, v16, v17
    v_cvt_pk_bf16_f32 v17, v18, v19
    ds_write_b32 v160, v16
    ds_write_b32 v161, v17 offset:256
    ds_read_b128 v[164:167], v162 offset:0
    ds_read_b128 v[168:171], v162 offset:64
    ds_read_b128 v[172:175], v162 offset:128
    ds_read_b128 v[176:179], v162 offset:192
    ds_read_b128 v[180:183], v162 offset:256
    s_waitcnt vmcnt(0)
    global_load_lds_dwordx4 v163, s[62:63]
    s_add_u32 m0, m0, 1024
    v_add_u32 v163, 61440, v163
    global_load_lds_dwordx4 v163, s[62:63]
    s_add_u32 m0, m0, 1024
    v_add_u32 v163, 61440, v163
    global_load_lds_dwordx4 v163, s[62:63]
    s_add_u32 m0, m0, 1024
    v_add_u32 v163, 61440, v163
    global_load_lds_dwordx4 v163, s[62:63]
    s_add_u32 m0, m0, 1024
    v_add_u32 v163, 61440, v163
    global_load_lds_dwordx4 v163, s[62:63]
    v_mul_f32 v14, s86, v152
    v_fma_f32 v15, v152, s86, -v14
    v_fmac_f32 v15, 849703008, v152
    v_exp_f32 v14, v14
    v_mul_f32 v15, 1060205080, v15
    v_fmac_f32 v14, v14, v15
    v_cmp_eq_u32 vcc, 0, v1
    v_cvt_pk_bf16_f32 v14, v14, v14
    v_lshlrev_b32 v152, 16, v14
    v_cndmask_b32 v104, 0, v154, vcc
LF_kpass:
    v_pk_mul_f32 v[22:23], v[134:135], v[152:153] op_sel_hi:[1,0]
    v_pk_mul_f32 v[22:23], v[22:23], s[86:87]
    v_pk_mul_f32 v[20:21], v[138:139], v[136:137] op_sel_hi:[1,0]
    v_mul_f32 v16, 1090519040, v22
    v_mul_f32 v17, 1090519040, v23
    v_mul_f32 v18, 1132462080, v22
    v_mul_f32 v19, 1132462080, v23
    v_fract_f32 v15, v23
    v_fract_f32 v17, v17
    v_fract_f32 v19, v19
    v_exp_f32 v14, v22
    v_exp_f32 v16, v16
    v_exp_f32 v18, v18
    v_pk_fma_f32 v[56:57], v[138:139], v[136:137], v[20:21] op_sel:[1,1,0] op_sel_hi:[0,1,1] neg_lo:[1,0,0]
    v_cos_f32 v24, v15
    v_sin_f32 v25, v15
    v_cos_f32 v26, v17
    v_sin_f32 v27, v17
    v_cos_f32 v28, v19
    v_sin_f32 v29, v19
    v_pk_mul_f32 v[56:57], v[56:57], v[152:153] op_sel_hi:[1,0]
    v_pk_mul_f32 v[24:25], v[24:25], v[14:15] op_sel_hi:[1,0]
    v_pk_mul_f32 v[26:27], v[26:27], v[16:17] op_sel_hi:[1,0]
    v_pk_mul_f32 v[28:29], v[28:29], v[18:19] op_sel_hi:[1,0]
    v_pk_mov_b32 v[134:135], v[140:141], v[140:141] op_sel:[0,1]
    v_pk_mov_b32 v[136:137], v[142:143], v[142:143] op_sel:[0,1]
    v_pk_mov_b32 v[138:139], v[144:145], v[144:145] op_sel:[0,1]
    v_pk_mov_b32 v[140:141], v[146:147], v[146:147] op_sel:[0,1]
    v_pk_mov_b32 v[142:143], v[148:149], v[148:149] op_sel:[0,1]
    v_pk_mov_b32 v[144:145], v[150:151], v[150:151] op_sel:[0,1]
    v_pk_mul_f32 v[14:15], v[24:25], v[24:25] op_sel_hi:[1,0]
    v_pk_mul_f32 v[16:17], v[26:27], v[26:27] op_sel_hi:[1,0]
    v_pk_mul_f32 v[18:19], v[28:29], v[28:29] op_sel_hi:[1,0]
    v_pk_mul_f32 v[20:21], v[56:57], v[26:27] op_sel_hi:[1,0]
    v_pk_fma_f32 v[30:31], v[24:25], v[24:25], v[14:15] op_sel:[1,1,0] op_sel_hi:[0,1,1] neg_lo:[1,0,0]
    v_pk_fma_f32 v[42:43], v[26:27], v[26:27], v[16:17] op_sel:[1,1,0] op_sel_hi:[0,1,1] neg_lo:[1,0,0]
    v_pk_fma_f32 v[54:55], v[28:29], v[28:29], v[18:19] op_sel:[1,1,0] op_sel_hi:[0,1,1] neg_lo:[1,0,0]
    v_pk_fma_f32 v[58:59], v[56:57], v[26:27], v[20:21] op_sel:[1,1,0] op_sel_hi:[0,1,1] neg_lo:[1,0,0]
    v_pk_mul_f32 v[14:15], v[30:31], v[24:25] op_sel_hi:[1,0]
    v_pk_mul_f32 v[16:17], v[30:31], v[30:31] op_sel_hi:[1,0]
    v_pk_mul_f32 v[18:19], v[42:43], v[42:43] op_sel_hi:[1,0]
    v_pk_mul_f32 v[20:21], v[28:29], v[30:31] op_sel_hi:[1,0]
    v_pk_fma_f32 v[32:33], v[30:31], v[24:25], v[14:15] op_sel:[1,1,0] op_sel_hi:[0,1,1] neg_lo:[1,0,0]
    v_pk_fma_f32 v[34:35], v[30:31], v[30:31], v[16:17] op_sel:[1,1,0] op_sel_hi:[0,1,1] neg_lo:[1,0,0]
    v_pk_fma_f32 v[44:45], v[42:43], v[42:43], v[18:19] op_sel:[1,1,0] op_sel_hi:[0,1,1] neg_lo:[1,0,0]
    v_pk_fma_f32 v[46:47], v[28:29], v[30:31], v[20:21] op_sel:[1,1,0] op_sel_hi:[0,1,1] neg_lo:[1,0,0]
    v_pk_mul_f32 v[14:15], v[56:57], v[42:43] op_sel_hi:[1,0]
    v_pk_mul_f32 v[16:17], v[58:59], v[42:43] op_sel_hi:[1,0]
    v_pk_mul_f32 v[18:19], v[34:35], v[24:25] op_sel_hi:[1,0]
    v_pk_mul_f32 v[20:21], v[34:35], v[30:31] op_sel_hi:[1,0]
    v_pk_fma_f32 v[60:61], v[56:57], v[42:43], v[14:15] op_sel:[1,1,0] op_sel_hi:[0,1,1] neg_lo:[1,0,0]
    v_pk_fma_f32 v[62:63], v[58:59], v[42:43], v[16:17] op_sel:[1,1,0] op_sel_hi:[0,1,1] neg_lo:[1,0,0]
    v_pk_fma_f32 v[36:37], v[34:35], v[24:25], v[18:19] op_sel:[1,1,0] op_sel_hi:[0,1,1] neg_lo:[1,0,0]
    v_pk_fma_f32 v[38:39], v[34:35], v[30:31], v[20:21] op_sel:[1,1,0] op_sel_hi:[0,1,1] neg_lo:[1,0,0]
    v_pk_mul_f32 v[14:15], v[34:35], v[32:33] op_sel_hi:[1,0]
    v_pk_mul_f32 v[16:17], v[28:29], v[34:35] op_sel_hi:[1,0]
    v_pk_mul_f32 v[18:19], v[28:29], v[26:27] op_sel_hi:[1,0]
    v_pk_mul_f32 v[20:21], v[56:57], v[44:45] op_sel_hi:[1,0]
    v_pk_fma_f32 v[40:41], v[34:35], v[32:33], v[14:15] op_sel:[1,1,0] op_sel_hi:[0,1,1] neg_lo:[1,0,0]
    v_pk_fma_f32 v[48:49], v[28:29], v[34:35], v[16:17] op_sel:[1,1,0] op_sel_hi:[0,1,1] neg_lo:[1,0,0]
    v_pk_fma_f32 v[52:53], v[28:29], v[26:27], v[18:19] op_sel:[1,1,0] op_sel_hi:[0,1,1] neg_lo:[1,0,0]
    v_pk_fma_f32 v[64:65], v[56:57], v[44:45], v[20:21] op_sel:[1,1,0] op_sel_hi:[0,1,1] neg_lo:[1,0,0]
    v_pk_mul_f32 v[14:15], v[28:29], v[38:39] op_sel_hi:[1,0]
    v_pk_mul_f32 v[16:17], v[58:59], v[44:45] op_sel_hi:[1,0]
    v_pk_mul_f32 v[18:19], v[60:61], v[44:45] op_sel_hi:[1,0]
    v_pk_mul_f32 v[20:21], v[62:63], v[44:45] op_sel_hi:[1,0]
    v_pk_fma_f32 v[50:51], v[28:29], v[38:39], v[14:15] op_sel:[1,1,0] op_sel_hi:[0,1,1] neg_lo:[1,0,0]
    v_pk_fma_f32 v[66:67], v[58:59], v[44:45], v[16:17] op_sel:[1,1,0] op_sel_hi:[0,1,1] neg_lo:[1,0,0]
    v_pk_fma_f32 v[68:69], v[60:61], v[44:45], v[18:19] op_sel:[1,1,0] op_sel_hi:[0,1,1] neg_lo:[1,0,0]
    v_pk_fma_f32 v[70:71], v[62:63], v[44:45], v[20:21] op_sel:[1,1,0] op_sel_hi:[0,1,1] neg_lo:[1,0,0]
    v_cvt_pk_bf16_f32 v72, 1.0, v24
    v_cvt_pk_bf16_f32 v73, v30, v32
    v_cvt_pk_bf16_f32 v74, v34, v36
    v_cvt_pk_bf16_f32 v75, v38, v40
    ds_write_b128 v120, v[72:75] offset:0
    v_pk_mul_f32 v[14:15], v[54:55], v[34:35] op_sel_hi:[1,0]
    v_pk_mul_f32 v[16:17], v[54:55], v[26:27] op_sel_hi:[1,0]
    v_pk_mul_f32 v[18:19], v[54:55], v[28:29] op_sel_hi:[1,0]
    v_pk_mul_f32 v[20:21], v[54:55], v[54:55] op_sel_hi:[1,0]
    v_pk_fma_f32 v[88:89], v[54:55], v[34:35], v[14:15] op_sel:[1,1,0] op_sel_hi:[0,1,1] neg_lo:[1,0,0]
    v_pk_fma_f32 v[90:91], v[54:55], v[26:27], v[16:17] op_sel:[1,1,0] op_sel_hi:[0,1,1] neg_lo:[1,0,0]
    v_pk_fma_f32 v[92:93], v[54:55], v[28:29], v[18:19] op_sel:[1,1,0] op_sel_hi:[0,1,1] neg_lo:[1,0,0]
    v_pk_fma_f32 v[94:95], v[54:55], v[54:55], v[20:21] op_sel:[1,1,0] op_sel_hi:[0,1,1] neg_lo:[1,0,0]
    v_cvt_pk_bf16_f32 v76, 0, -v25
    v_cvt_pk_bf16_f32 v77, -v31, -v33
    v_cvt_pk_bf16_f32 v78, -v35, -v37
    v_cvt_pk_bf16_f32 v79, -v39, -v41
    ds_write_b128 v120, v[76:79] offset:9216
    v_cvt_pk_bf16_f32 v80, v28, v28
    v_cvt_pk_bf16_f32 v81, v46, v48
    v_cvt_pk_bf16_f32 v82, v48, v48
    v_cvt_pk_bf16_f32 v83, v50, v52
    ds_write_b128 v120, v[80:83] offset:16
    v_pk_mul_f32 v[14:15], v[92:93], v[34:35] op_sel_hi:[1,0]
    v_pk_mul_f32 v[16:17], v[94:95], v[28:29] op_sel_hi:[1,0]
    v_pk_mul_f32 v[18:19], v[94:95], v[54:55] op_sel_hi:[1,0]
    v_pk_mul_f32 v[20:21], v[94:95], v[92:93] op_sel_hi:[1,0]
    v_pk_fma_f32 v[96:97], v[92:93], v[34:35], v[14:15] op_sel:[1,1,0] op_sel_hi:[0,1,1] neg_lo:[1,0,0]
    v_pk_fma_f32 v[98:99], v[94:95], v[28:29], v[16:17] op_sel:[1,1,0] op_sel_hi:[0,1,1] neg_lo:[1,0,0]
    v_pk_fma_f32 v[100:101], v[94:95], v[54:55], v[18:19] op_sel:[1,1,0] op_sel_hi:[0,1,1] neg_lo:[1,0,0]
    v_pk_fma_f32 v[102:103], v[94:95], v[92:93], v[20:21] op_sel:[1,1,0] op_sel_hi:[0,1,1] neg_lo:[1,0,0]
    v_cvt_pk_bf16_f32 v84, -v29, -v29
    v_cvt_pk_bf16_f32 v85, -v47, -v49
    v_cvt_pk_bf16_f32 v86, -v49, -v49
    v_cvt_pk_bf16_f32 v87, -v51, -v53
    ds_write_b128 v120, v[84:87] offset:9232
    v_cvt_pk_bf16_f32 v72, v56, v58
    v_cvt_pk_bf16_f32 v73, v60, v62
    v_cvt_pk_bf16_f32 v74, v64, v66
    v_cvt_pk_bf16_f32 v75, v68, v70
    ds_write_b128 v120, v[72:75] offset:64
    v_pk_mul_f32 v[14:15], v[64:65], v[44:45] op_sel_hi:[1,0]
    v_pk_mul_f32 v[16:17], v[66:67], v[44:45] op_sel_hi:[1,0]
    v_pk_mul_f32 v[18:19], v[68:69], v[44:45] op_sel_hi:[1,0]
    v_pk_mul_f32 v[20:21], v[70:71], v[44:45] op_sel_hi:[1,0]
    v_pk_fma_f32 v[46:47], v[64:65], v[44:45], v[14:15] op_sel:[1,1,0] op_sel_hi:[0,1,1] neg_lo:[1,0,0]
    v_pk_fma_f32 v[48:49], v[66:67], v[44:45], v[16:17] op_sel:[1,1,0] op_sel_hi:[0,1,1] neg_lo:[1,0,0]
    v_pk_fma_f32 v[50:51], v[68:69], v[44:45], v[18:19] op_sel:[1,1,0] op_sel_hi:[0,1,1] neg_lo:[1,0,0]
    v_pk_fma_f32 v[52:53], v[70:71], v[44:45], v[20:21] op_sel:[1,1,0] op_sel_hi:[0,1,1] neg_lo:[1,0,0]
    v_cvt_pk_bf16_f32 v76, v57, v59
    v_cvt_pk_bf16_f32 v77, v61, v63
    v_cvt_pk_bf16_f32 v78, v65, v67
    v_cvt_pk_bf16_f32 v79, v69, v71
    ds_write_b128 v120, v[76:79] offset:9280
    v_cvt_pk_bf16_f32 v80, v54, v54
    v_cvt_pk_bf16_f32 v81, v54, v88
    v_cvt_pk_bf16_f32 v82, v88, v88
    v_cvt_pk_bf16_f32 v83, v90, v90
    ds_write_b128 v120, v[80:83] offset:32
    v_pk_mul_f32 v[14:15], v[46:47], v[44:45] op_sel_hi:[1,0]
    v_pk_mul_f32 v[16:17], v[48:49], v[44:45] op_sel_hi:[1,0]
    v_pk_mul_f32 v[18:19], v[50:51], v[44:45] op_sel_hi:[1,0]
    v_pk_mul_f32 v[20:21], v[52:53], v[44:45] op_sel_hi:[1,0]
    v_pk_fma_f32 v[30:31], v[46:47], v[44:45], v[14:15] op_sel:[1,1,0] op_sel_hi:[0,1,1] neg_lo:[1,0,0]
    v_pk_fma_f32 v[32:33], v[48:49], v[44:45], v[16:17] op_sel:[1,1,0] op_sel_hi:[0,1,1] neg_lo:[1,0,0]
    v_pk_fma_f32 v[36:37], v[50:51], v[44:45], v[18:19] op_sel:[1,1,0] op_sel_hi:[0,1,1] neg_lo:[1,0,0]
    v_pk_fma_f32 v[40:41], v[52:53], v[44:45], v[20:21] op_sel:[1,1,0] op_sel_hi:[0,1,1] neg_lo:[1,0,0]
    v_cvt_pk_bf16_f32 v84, -v55, -v55
    v_cvt_pk_bf16_f32 v85, -v55, -v89
    v_cvt_pk_bf16_f32 v86, -v89, -v89
    v_cvt_pk_bf16_f32 v87, -v91, -v91
    ds_write_b128 v120, v[84:87] offset:9248
    s_cmp_eq_u32 s3, 1
    s_cbranch_scc1 LF_cmod
    s_cmp_eq_u32 s3, 2
    s_cbranch_scc1 LF_pol1
LF_noarr1:
    v_pk_mul_f32 v[14:15], v[94:95], v[94:95] op_sel_hi:[1,0]
    v_pk_mul_f32 v[16:17], v[30:31], v[44:45] op_sel_hi:[1,0]
    v_pk_mul_f32 v[18:19], v[32:33], v[44:45] op_sel_hi:[1,0]
    v_pk_mul_f32 v[20:21], v[36:37], v[44:45] op_sel_hi:[1,0]
    v_pk_fma_f32 v[24:25], v[94:95], v[94:95], v[14:15] op_sel:[1,1,0] op_sel_hi:[0,1,1] neg_lo:[1,0,0]
    v_pk_fma_f32 v[56:57], v[30:31], v[44:45], v[16:17] op_sel:[1,1,0] op_sel_hi:[0,1,1] neg_lo:[1,0,0]
    v_pk_fma_f32 v[58:59], v[32:33], v[44:45], v[18:19] op_sel:[1,1,0] op_sel_hi:[0,1,1] neg_lo:[1,0,0]
    v_pk_fma_f32 v[60:61], v[36:37], v[44:45], v[20:21] op_sel:[1,1,0] op_sel_hi:[0,1,1] neg_lo:[1,0,0]
    v_cvt_pk_bf16_f32 v72, v46, v48
    v_cvt_pk_bf16_f32 v73, v50, v52
    v_cvt_pk_bf16_f32 v74, v30, v32
    v_cvt_pk_bf16_f32 v75, v36, v40
    ds_write_b128 v120, v[72:75] offset:80
    v_pk_mul_f32 v[14:15], v[40:41], v[44:45] op_sel_hi:[1,0]
    v_pk_mul_f32 v[16:17], v[56:57], v[44:45] op_sel_hi:[1,0]
    v_pk_mul_f32 v[18:19], v[58:59], v[44:45] op_sel_hi:[1,0]
    v_pk_mul_f32 v[20:21], v[60:61], v[44:45] op_sel_hi:[1,0]
    v_pk_fma_f32 v[62:63], v[40:41], v[44:45], v[14:15] op_sel:[1,1,0] op_sel_hi:[0,1,1] neg_lo:[1,0,0]
    v_pk_fma_f32 v[64:65], v[56:57], v[44:45], v[16:17] op_sel:[1,1,0] op_sel_hi:[0,1,1] neg_lo:[1,0,0]
    v_pk_fma_f32 v[66:67], v[58:59], v[44:45], v[18:19] op_sel:[1,1,0] op_sel_hi:[0,1,1] neg_lo:[1,0,0]
    v_pk_fma_f32 v[68:69], v[60:61], v[44:45], v[20:21] op_sel:[1,1,0] op_sel_hi:[0,1,1] neg_lo:[1,0,0]
    v_cvt_pk_bf16_f32 v76, v47, v49
    v_cvt_pk_bf16_f32 v77, v51, v53
    v_cvt_pk_bf16_f32 v78, v31, v33
    v_cvt_pk_bf16_f32 v79, v37, v41
    ds_write_b128 v120, v[76:79] offset:9296
    v_cvt_pk_bf16_f32 v80, v92, v94
    v_cvt_pk_bf16_f32 v81, v100, v24
    v_cvt_pk_bf16_f32 v82, v96, v98
    v_cvt_pk_bf16_f32 v83, v102, v94
    ds_write_b128 v120, v[80:83] offset:48
    v_pk_mul_f32 v[14:15], v[62:63], v[44:45] op_sel_hi:[1,0]
    v_pk_mul_f32 v[16:17], v[64:65], v[44:45] op_sel_hi:[1,0]
    v_pk_mul_f32 v[18:19], v[66:67], v[44:45] op_sel_hi:[1,0]
    v_pk_mul_f32 v[20:21], v[68:69], v[44:45] op_sel_hi:[1,0]
    v_pk_fma_f32 v[70:71], v[62:63], v[44:45], v[14:15] op_sel:[1,1,0] op_sel_hi:[0,1,1] neg_lo:[1,0,0]
    v_pk_fma_f32 v[46:47], v[64:65], v[44:45], v[16:17] op_sel:[1,1,0] op_sel_hi:[0,1,1] neg_lo:[1,0,0]
    v_pk_fma_f32 v[48:49], v[66:67], v[44:45], v[18:19] op_sel:[1,1,0] op_sel_hi:[0,1,1] neg_lo:[1,0,0]
    v_pk_fma_f32 v[50:51], v[68:69], v[44:45], v[20:21] op_sel:[1,1,0] op_sel_hi:[0,1,1] neg_lo:[1,0,0]
    v_cvt_pk_bf16_f32 v84, -v93, -v95
    v_cvt_pk_bf16_f32 v85, -v101, -v25
    v_cvt_pk_bf16_f32 v86, -v97, -v99
    v_cvt_pk_bf16_f32 v87, -v103, -v95
    ds_write_b128 v120, v[84:87] offset:9264
    v_cvt_pk_bf16_f32 v72, v56, v58
    v_cvt_pk_bf16_f32 v73, v60, v62
    v_cvt_pk_bf16_f32 v74, v64, v66
    v_cvt_pk_bf16_f32 v75, v68, v70
    ds_write_b128 v120, v[72:75] offset:96
    v_pk_mul_f32 v[14:15], v[70:71], v[44:45] op_sel_hi:[1,0]
    v_pk_mul_f32 v[16:17], v[46:47], v[44:45] op_sel_hi:[1,0]
    v_pk_mul_f32 v[18:19], v[48:49], v[44:45] op_sel_hi:[1,0]
    v_pk_mul_f32 v[20:21], v[50:51], v[44:45] op_sel_hi:[1,0]
    v_pk_fma_f32 v[52:53], v[70:71], v[44:45], v[14:15] op_sel:[1,1,0] op_sel_hi:[0,1,1] neg_lo:[1,0,0]
    v_pk_fma_f32 v[30:31], v[46:47], v[44:45], v[16:17] op_sel:[1,1,0] op_sel_hi:[0,1,1] neg_lo:[1,0,0]
    v_pk_fma_f32 v[32:33], v[48:49], v[44:45], v[18:19] op_sel:[1,1,0] op_sel_hi:[0,1,1] neg_lo:[1,0,0]
    v_pk_fma_f32 v[36:37], v[50:51], v[44:45], v[20:21] op_sel:[1,1,0] op_sel_hi:[0,1,1] neg_lo:[1,0,0]
    v_cvt_pk_bf16_f32 v76, v57, v59
    v_cvt_pk_bf16_f32 v77, v61, v63
    v_cvt_pk_bf16_f32 v78, v65, v67
    v_cvt_pk_bf16_f32 v79, v69, v71
    ds_write_b128 v120, v[76:79] offset:9312
    v_pk_mul_f32 v[14:15], v[52:53], v[44:45] op_sel_hi:[1,0]
    v_pk_fma_f32 v[40:41], v[52:53], v[44:45], v[14:15] op_sel:[1,1,0] op_sel_hi:[0,1,1] neg_lo:[1,0,0]
    v_cvt_pk_bf16_f32 v80, v46, v48
    v_cvt_pk_bf16_f32 v81, v50, v52
    v_cvt_pk_bf16_f32 v82, v30, v32
    v_cvt_pk_bf16_f32 v83, v36, v40
    ds_write_b128 v120, v[80:83] offset:112
    v_cvt_pk_bf16_f32 v84, v47, v49
    v_cvt_pk_bf16_f32 v85, v51, v53
    v_cvt_pk_bf16_f32 v86, v31, v33
    v_cvt_pk_bf16_f32 v87, v37, v41
    ds_write_b128 v120, v[84:87] offset:9328
    s_cmp_eq_u32 s3, 2
    s_cbranch_scc1 LF_pol2
LF_nopoll1:
    ds_read_b64_tr_b16 v[56:57], v121 offset:0
    ds_read_b64_tr_b16 v[58:59], v121 offset:144
    ds_read_b64_tr_b16 v[60:61], v121 offset:64
    ds_read_b64_tr_b16 v[62:63], v121 offset:208
    ds_read_b64_tr_b16 v[64:65], v121 offset:2304
    ds_read_b64_tr_b16 v[66:67], v121 offset:2448
    ds_read_b64_tr_b16 v[68:69], v121 offset:2368
    ds_read_b64_tr_b16 v[70:71], v121 offset:2512
    ds_read_b64_tr_b16 v[72:73], v121 offset:4608
    ds_read_b64_tr_b16 v[74:75], v121 offset:4752
    ds_read_b64_tr_b16 v[76:77], v121 offset:4672
    ds_read_b64_tr_b16 v[78:79], v121 offset:4816
    s_waitcnt lgkmcnt(8)
    v_mfma_f32_32x32x16_bf16 v[104:119], v[56:59], v[60:63], v[104:119]
    ds_read_b64_tr_b16 v[80:81], v121 offset:6912
    ds_read_b64_tr_b16 v[82:83], v121 offset:7056
    ds_read_b64_tr_b16 v[84:85], v121 offset:6976
    ds_read_b64_tr_b16 v[86:87], v121 offset:7120
    s_waitcnt lgkmcnt(8)
    v_mfma_f32_32x32x16_bf16 v[104:119], v[64:67], v[68:71], v[104:119]
    ds_read_b64_tr_b16 v[56:57], v121 offset:9216
    ds_read_b64_tr_b16 v[58:59], v121 offset:9360
    ds_read_b64_tr_b16 v[60:61], v121 offset:9280
    ds_read_b64_tr_b16 v[62:63], v121 offset:9424
    s_waitcnt lgkmcnt(8)
    v_mfma_f32_32x32x16_bf16 v[104:119], v[72:75], v[76:79], v[104:119]
    ds_read_b64_tr_b16 v[64:65], v121 offset:11520
    ds_read_b64_tr_b16 v[66:67], v121 offset:11664
    ds_read_b64_tr_b16 v[68:69], v121 offset:11584
    ds_read_b64_tr_b16 v[70:71], v121 offset:11728
    s_waitcnt lgkmcnt(8)
    v_mfma_f32_32x32x16_bf16 v[104:119], v[80:83], v[84:87], v[104:119]
    ds_read_b64_tr_b16 v[72:73], v121 offset:13824
    ds_read_b64_tr_b16 v[74:75], v121 offset:13968
    ds_read_b64_tr_b16 v[76:77], v121 offset:13888
    ds_read_b64_tr_b16 v[78:79], v121 offset:14032
    s_waitcnt lgkmcnt(8)
    v_mfma_f32_32x32x16_bf16 v[104:119], v[56:59], v[60:63], v[104:119]
    ds_read_b64_tr_b16 v[80:81], v121 offset:16128
    ds_read_b64_tr_b16 v[82:83], v121 offset:16272
    ds_read_b64_tr_b16 v[84:85], v121 offset:16192
    ds_read_b64_tr_b16 v[86:87], v121 offset:16336
    s_waitcnt lgkmcnt(8)
    v_mfma_f32_32x32x16_bf16 v[104:119], v[64:67], v[68:71], v[104:119]
    s_waitcnt lgkmcnt(4)
    v_mfma_f32_32x32x16_bf16 v[104:119], v[72:75], v[76:79], v[104:119]
    s_waitcnt lgkmcnt(0)
    v_mfma_f32_32x32x16_bf16 v[104:119], v[80:83], v[84:87], v[104:119]
    s_cmp_eq_u32 s3, 1
    s_cbranch_scc1 LF_arr1
    s_cmp_eq_u32 s3, 0
    s_mov_b32 s3, 1
    s_cbranch_scc1 LF_kpass
    s_cmp_eq_u32 s21, 0
    s_cbranch_scc0 LF_haven
    s_waitcnt vmcnt(1)
    v_cmp_gt_u32 vcc, v133, v122
    s_cbranch_vccz LF_haven
    s_waitcnt vmcnt(0)
    v_mov_b32 v122, v155
    v_cmp_gt_u32 vcc, v133, v122
    s_cbranch_vccnz LF_spins1
LF_gos1:
LF_haven:
    s_barrier
    global_load_dwordx4 v[184:187], v237, s[68:69] offset:0 sc1
    global_load_dwordx4 v[188:191], v237, s[68:69] offset:64 sc1
    global_load_dwordx4 v[192:195], v237, s[68:69] offset:128 sc1
    global_load_dwordx4 v[196:199], v237, s[68:69] offset:192 sc1
    global_load_dword v200, v239, s[68:69] sc1
    v_cmp_ne_u32 vcc, 33, v1
    s_mul_i32 s26, s21, 8448
    s_add_u32 s26, s26, 107520
    v_add_u32 v14, s26, v8
    v_cvt_pk_bf16_f32 v24, v104, v105
    v_cvt_pk_bf16_f32 v25, v106, v107
    v_cvt_pk_bf16_f32 v26, v108, v109
    v_cvt_pk_bf16_f32 v27, v110, v111
    ds_write_b64 v130, v[24:25] offset:32
    v_cvt_pk_bf16_f32 v28, v112, v113
    v_cvt_pk_bf16_f32 v29, v114, v115
    ds_write_b64 v130, v[26:27] offset:544
    v_cvt_pk_bf16_f32 v30, v112, v116
    v_cndmask_b32 v29, 0, v29, vcc
    ds_write_b16 v125, v30
    v_cvt_pk_bf16_f32 v31, v117, v118
    ds_write_b64 v131, v[28:29] offset:1056
    v_cvt_pk_bf16_f32 v32, v119, v119
    ds_write_b16_d16_hi v124, v30 offset:1214
    ds_write_b16 v127, v31
    ds_write_b16 v128, v31
    ds_write_b16_d16_hi v126, v31 offset:64
    ds_write_b16 v129, v32
    ds_read_b128 v[24:27], v132
    ds_read_b64 v[28:29], v132 offset:16
    ds_read_b128 v[48:51], v132 offset:1024
    ds_read_b64 v[52:53], v132 offset:1040
    s_waitcnt lgkmcnt(2)
    ds_write_b128 v14, v[26:29] offset:6336
    v_alignbit_b32 v32, v25, v24, 16
    v_alignbit_b32 v33, v26, v25, 16
    v_alignbit_b32 v34, v27, v26, 16
    v_alignbit_b32 v35, v28, v27, 16
    ds_write_b128 v14, v[32:35] offset:0
    v_mov_b32 v36, v25
    v_mov_b32 v37, v26
    v_mov_b32 v38, v27
    v_mov_b32 v39, v28
    ds_write_b128 v14, v[36:39] offset:2112
    v_alignbit_b32 v40, v26, v25, 16
    v_alignbit_b32 v41, v27, v26, 16
    v_alignbit_b32 v42, v28, v27, 16
    v_alignbit_b32 v43, v29, v28, 16
    ds_write_b128 v14, v[40:43] offset:4224
    s_waitcnt lgkmcnt(4)
    ds_write_b128 v14, v[50:53] offset:7360
    v_alignbit_b32 v56, v49, v48, 16
    v_alignbit_b32 v57, v50, v49, 16
    v_alignbit_b32 v58, v51, v50, 16
    v_alignbit_b32 v59, v52, v51, 16
    ds_write_b128 v14, v[56:59] offset:1024
    v_mov_b32 v60, v49
    v_mov_b32 v61, v50
    v_mov_b32 v62, v51
    v_mov_b32 v63, v52
    ds_write_b128 v14, v[60:63] offset:3136
    v_alignbit_b32 v64, v50, v49, 16
    v_alignbit_b32 v65, v51, v50, 16
    v_alignbit_b32 v66, v52, v51, 16
    v_alignbit_b32 v67, v53, v52, 16
    ds_write_b128 v14, v[64:67] offset:5248
    ds_read_b64_tr_b16 a[128:129], v240 offset:8
    ds_read_b64_tr_b16 a[130:131], v240 offset:0
    ds_read_b64_tr_b16 a[132:133], v240 offset:72
    ds_read_b64_tr_b16 a[134:135], v240 offset:64
    ds_read_b64_tr_b16 a[136:137], v240 offset:136
    ds_read_b64_tr_b16 a[138:139], v240 offset:128
    ds_read_b64_tr_b16 a[140:141], v240 offset:200
    ds_read_b64_tr_b16 a[142:143], v240 offset:192
    ds_read_b64_tr_b16 a[144:145], v240 offset:264
    ds_read_b64_tr_b16 a[146:147], v240 offset:256
    ds_read_b64_tr_b16 a[148:149], v240 offset:328
    ds_read_b64_tr_b16 a[150:151], v240 offset:320
    ds_read_b64_tr_b16 a[152:153], v240 offset:392
    ds_read_b64_tr_b16 a[154:155], v240 offset:384
    ds_read_b64_tr_b16 a[156:157], v240 offset:456
    ds_read_b64_tr_b16 a[158:159], v240 offset:448
    ds_read_b64_tr_b16 a[160:161], v240 offset:520
    ds_read_b64_tr_b16 a[162:163], v240 offset:512
    ds_read_b64_tr_b16 a[164:165], v240 offset:584
    ds_read_b64_tr_b16 a[166:167], v240 offset:576
    ds_read_b64_tr_b16 a[168:169], v240 offset:648
    ds_read_b64_tr_b16 a[170:171], v240 offset:640
    ds_read_b64_tr_b16 a[172:173], v240 offset:712
    ds_read_b64_tr_b16 a[174:175], v240 offset:704
    ds_read_b64_tr_b16 a[176:177], v240 offset:776
    ds_read_b64_tr_b16 a[178:179], v240 offset:768
    ds_read_b64_tr_b16 a[180:181], v240 offset:840
    ds_read_b64_tr_b16 a[182:183], v240 offset:832
    ds_read_b64_tr_b16 a[184:185], v240 offset:904
    ds_read_b64_tr_b16 a[186:187], v240 offset:896
    ds_read_b64_tr_b16 a[188:189], v240 offset:968
    ds_read_b64_tr_b16 a[190:191], v240 offset:960
    ds_read_b64_tr_b16 a[192:193], v240 offset:1032
    ds_read_b64_tr_b16 a[194:195], v240 offset:1024
    ds_read_b64_tr_b16 a[196:197], v240 offset:1096
    ds_read_b64_tr_b16 a[198:199], v240 offset:1088
    ds_read_b64_tr_b16 a[200:201], v241 offset:1168
    ds_read_b64_tr_b16 a[202:203], v241 offset:1152
    ds_read_b64_tr_b16 a[204:205], v241 offset:1200
    ds_read_b64_tr_b16 a[206:207], v241 offset:1184
    ds_read_b64_tr_b16 a[208:209], v241 offset:1232
    ds_read_b64_tr_b16 a[210:211], v241 offset:1216
    ds_read_b64_tr_b16 a[212:213], v241 offset:1264
    ds_read_b64_tr_b16 a[214:215], v241 offset:1248
    ds_read_b64_tr_b16 a[216:217], v241 offset:1296
    ds_read_b64_tr_b16 a[218:219], v241 offset:1280
    ds_read_b64_tr_b16 a[220:221], v241 offset:1328
    ds_read_b64_tr_b16 a[222:223], v241 offset:1312
    ds_read_b64_tr_b16 a[224:225], v242 offset:1552
    ds_read_b64_tr_b16 a[226:227], v242 offset:1536
    ds_read_b64_tr_b16 a[228:229], v242 offset:1584
    ds_read_b64_tr_b16 a[230:231], v242 offset:1568
    ds_read_b64_tr_b16 a[232:233], v242 offset:1616
    ds_read_b64_tr_b16 a[234:235], v242 offset:1600
    ds_read_b64_tr_b16 a[236:237], v242 offset:1648
    ds_read_b64_tr_b16 a[238:239], v242 offset:1632
    s_lshl_b32 s29, s20, 12
    s_add_u32 s29, s29, 10485760
    s_add_u32 s34, s68, s29
    s_addc_u32 s35, s69, 0
    s_lshl_b32 s28, s21, 12
    s_add_u32 m0, s28, 64064
    s_mul_i32 s27, s21, 16016
    v_mov_b32 v12, 0
    v_mov_b32 v13, 0
    v_mov_b32 v14, 0
    v_mov_b32 v15, 0
    v_min_u32 v17, 29, v1
    v_lshl_add_u32 v17, v17, 4, s27
    v_min_u32 v18, 3, v1
    v_mul_u32_u24 v18, 3088, v18
    v_add_u32 v18, s27, v18
    s_add_u32 s28, s21, 32
    s_waitcnt vmcnt(0)
    v_add_f32_dpp v40, v200, v200 row_ror:4 row_mask:0xf bank_mask:0xf
    s_nop 1
    v_add_f32_dpp v40, v40, v40 row_ror:8 row_mask:0xf bank_mask:0xf
    v_cvt_pk_bf16_f32 v40, v40, v40
    v_lshlrev_b32 v40, 16, v40
    ds_bpermute_b32 v42, v243, v40
    ds_bpermute_b32 v43, v243, v40 offset:64
    v_readlane_b32 s70, v40, s28
    s_waitcnt lgkmcnt(0)
    s_barrier
    v_add_f32 v43, 1.0, v43
    v_cvt_pk_bf16_f32 v43, v43, 0
    v_lshlrev_b32 v41, 16, v43
    ds_write_b128 v17, v[12:15]
    ds_write_b128 v18, v[12:15] offset:4576
    v_dot2_f32_bf16 v44, v184, v43, v42
    v_dot2_f32_bf16 v45, v184, v41, v42
    v_dot2_f32_bf16 v46, v185, v43, v42
    v_dot2_f32_bf16 v47, v185, v41, v42
    v_dot2_f32_bf16 v48, v186, v43, v42
    v_dot2_f32_bf16 v49, v186, v41, v42
    v_dot2_f32_bf16 v50, v187, v43, v42
    v_dot2_f32_bf16 v51, v187, v41, v42
    v_dot2_f32_bf16 v52, v188, v43, v42
    v_dot2_f32_bf16 v53, v188, v41, v42
    v_dot2_f32_bf16 v54, v189, v43, v42
    v_dot2_f32_bf16 v55, v189, v41, v42
    v_dot2_f32_bf16 v56, v190, v43, v42
    v_dot2_f32_bf16 v57, v190, v41, v42
    v_dot2_f32_bf16 v58, v191, v43, v42
    v_dot2_f32_bf16 v59, v191, v41, v42
    v_cvt_pk_bf16_f32 v76, v44, v45
    v_cvt_pk_bf16_f32 v77, v46, v47
    v_cvt_pk_bf16_f32 v78, v48, v49
    v_cvt_pk_bf16_f32 v79, v50, v51
    ds_write_b128 v236, v[76:79] offset:480
    v_dot2_f32_bf16 v60, v192, v43, v42
    v_dot2_f32_bf16 v61, v192, v41, v42
    v_dot2_f32_bf16 v62, v193, v43, v42
    v_dot2_f32_bf16 v63, v193, v41, v42
    v_dot2_f32_bf16 v64, v194, v43, v42
    v_dot2_f32_bf16 v65, v194, v41, v42
    v_dot2_f32_bf16 v66, v195, v43, v42
    v_dot2_f32_bf16 v67, v195, v41, v42
    v_cvt_pk_bf16_f32 v80, v52, v53
    v_cvt_pk_bf16_f32 v81, v54, v55
    v_cvt_pk_bf16_f32 v82, v56, v57
    v_cvt_pk_bf16_f32 v83, v58, v59
    ds_write_b128 v236, v[80:83] offset:496
    v_dot2_f32_bf16 v68, v196, v43, v42
    v_dot2_f32_bf16 v69, v196, v41, v42
    v_dot2_f32_bf16 v70, v197, v43, v42
    v_dot2_f32_bf16 v71, v197, v41, v42
    v_dot2_f32_bf16 v72, v198, v43, v42
    v_dot2_f32_bf16 v73, v198, v41, v42
    v_dot2_f32_bf16 v74, v199, v43, v42
    v_dot2_f32_bf16 v75, v199, v41, v42
    v_cvt_pk_bf16_f32 v84, v60, v61
    v_cvt_pk_bf16_f32 v85, v62, v63
    v_cvt_pk_bf16_f32 v86, v64, v65
    v_cvt_pk_bf16_f32 v87, v66, v67
    ds_write_b128 v236, v[84:87] offset:512
    v_cvt_pk_bf16_f32 v88, v68, v69
    v_cvt_pk_bf16_f32 v89, v70, v71
    v_cvt_pk_bf16_f32 v90, v72, v73
    v_cvt_pk_bf16_f32 v91, v74, v75
    ds_write_b128 v236, v[88:91] offset:528
    s_waitcnt lgkmcnt(0)
    s_barrier
    ds_read_b128 v[76:79], v230 offset:0
    ds_read_b128 v[80:83], v230 offset:64
    ds_read_b128 v[84:87], v230 offset:128
    ds_read_b128 v[88:91], v230 offset:192
    ds_read_b128 v[92:95], v230 offset:256
    ds_read_b128 v[96:99], v230 offset:320
    s_waitcnt lgkmcnt(5)
    v_mfma_f32_16x16x32_bf16 v[12:15], a[156:159], v[76:79], 0
    ds_read_b128 v[100:103], v230 offset:384
    v_bfe_u32 v205, v1, 2, 2
    v_lshrrev_b32 v206, 4, v1
    v_and_b32 v204, 3, v1
    v_mfma_f32_16x16x32_bf16 v[16:19], a[188:191], v[76:79], 0
    v_and_b32 v207, 15, v1
    s_and_b32 s24, s2, 7
    s_lshr_b32 s25, s2, 3
    global_load_lds_dwordx4 v238, s[68:69] offset:0 sc1
    s_waitcnt lgkmcnt(5)
    v_mfma_f32_16x16x32_bf16 v[12:15], a[152:155], v[80:83], v[12:15]
    ds_read_b128 v[104:107], v230 offset:448
    s_lshr_b32 s22, s24, 1
    s_lshl_b32 s22, s22, 3
    s_lshr_b32 s26, s25, 2
    v_mfma_f32_16x16x32_bf16 v[16:19], a[184:187], v[80:83], v[16:19]
    s_add_u32 s22, s22, s26
    s_and_b32 s23, s24, 1
    s_lshl_b32 s23, s23, 2
    global_load_lds_dwordx4 v238, s[68:69] offset:1024 sc1
    s_waitcnt lgkmcnt(5)
    v_mfma_f32_16x16x32_bf16 v[12:15], a[148:151], v[84:87], v[12:15]
    ds_read_b128 v[76:79], v230 offset:512
    s_and_b32 s26, s25, 3
    s_add_u32 s23, s23, s26
    s_mul_i32 s26, s23, 12
    v_mov_b32 v196, -1
    v_mfma_f32_16x16x32_bf16 v[16:19], a[180:183], v[84:87], v[16:19]
    s_mul_i32 s25, s21, 3
    s_add_u32 s25, s26, s25
    s_lshl_b32 s26, s25, 7
    global_load_lds_dwordx4 v238, s[68:69] offset:2048 sc1
    v_mov_b32 v197, -1
    s_waitcnt lgkmcnt(5)
    v_mfma_f32_16x16x32_bf16 v[12:15], a[144:147], v[88:91], v[12:15]
    ds_read_b128 v[80:83], v230 offset:576
    s_add_u32 s26, s26, 229376
    v_min_u32 v250, 11, v1
    v_lshrrev_b32 v251, 2, v250
    v_mov_b32 v198, -1
    v_mfma_f32_16x16x32_bf16 v[16:19], a[176:179], v[88:91], v[16:19]
    v_lshl_add_u32 v251, v251, 7, s26
    v_and_b32 v250, 3, v250
    v_lshl_add_u32 v251, v250, 2, v251
    global_load_lds_dwordx4 v238, s[68:69] offset:3072 sc1
    s_add_u32 m0, m0, 16384
    v_mov_b32 v199, -1
    s_waitcnt lgkmcnt(5)
    v_mfma_f32_16x16x32_bf16 v[12:15], a[140:143], v[92:95], v[12:15]
    ds_read_b128 v[84:87], v230 offset:640
    s_lshl_b32 s24, s23, 2
    s_add_u32 s24, s24, s21
    s_mul_i32 s24, s24, 61440
    v_mfma_f32_16x16x32_bf16 v[16:19], a[172:175], v[92:95], v[16:19]
    s_add_u32 s26, s24, 13631488
    s_add_u32 s4, s68, s26
    s_addc_u32 s5, s69, 0
    global_load_lds_dwordx4 v253, s[68:69] offset:0 sc1
    s_waitcnt lgkmcnt(5)
    v_mfma_f32_16x16x32_bf16 v[12:15], a[136:139], v[96:99], v[12:15]
    ds_read_b128 v[88:91], v230 offset:704
    s_mov_b32 s6, 61440
    s_mov_b32 s7, 0x20000
    s_add_u32 s26, s24, 15728640
    v_mfma_f32_16x16x32_bf16 v[16:19], a[168:171], v[96:99], v[16:19]
    s_add_u32 s8, s68, s26
    s_addc_u32 s9, s69, 0
    s_mov_b32 s10, 61440
    global_load_lds_dwordx4 v253, s[68:69] offset:1024 sc1
    s_waitcnt lgkmcnt(5)
    v_mfma_f32_16x16x32_bf16 v[12:15], a[132:135], v[100:103], v[12:15]
    ds_read_b128 v[92:95], v230 offset:768
    s_mov_b32 s11, 0x20000
    s_mul_i32 s26, s22, 196608
    s_add_u32 s26, s26, 17825792
    v_mfma_f32_16x16x32_bf16 v[16:19], a[164:167], v[100:103], v[16:19]
    s_add_u32 s12, s68, s26
    s_addc_u32 s13, s69, 0
    s_mov_b32 s14, 196608
    global_load_lds_dwordx4 v253, s[68:69] offset:2048 sc1
    s_waitcnt lgkmcnt(5)
    v_mfma_f32_16x16x32_bf16 v[12:15], a[128:131], v[104:107], v[12:15]
    ds_read_b128 v[96:99], v230 offset:832
    s_mov_b32 s15, 0x20000
    s_add_u32 s16, s64, 0
    s_addc_u32 s17, s65, 0
    global_store_dwordx4 v8, v[196:199], s[34:35] offset:0 sc1
    v_mfma_f32_16x16x32_bf16 v[16:19], a[160:163], v[104:107], v[16:19]
    s_mov_b32 s18, 2621440
    s_mov_b32 s19, 0x20000
    s_and_b32 s26, s21, 1
    global_load_lds_dwordx4 v253, s[68:69] offset:3072 sc1
    v_mfma_f32_16x16x32_bf16 v[20:23], a[192:195], v[104:107], 0
    s_lshl_b32 s25, s25, 6
    s_add_u32 s25, s25, 65536
    v_add_u32 v244, s26, v206
    v_mfma_f32_16x16x32_bf16 v[28:31], a[196:199], v[104:107], 0
    s_xor_b32 s26, s26, 1
    s_lshl_b32 s26, s26, 1
    v_mov_b32 v245, s26
    v_mfma_f32_16x16x32_bf16 v[108:111], v[214:217], v[104:107], 0
    v_cmp_gt_u32 vcc, 2, v206
    v_lshl_add_u32 v246, v207, 2, s25
    s_nop 0
    v_cndmask_b32 v244, v245, v244, vcc
    global_store_dwordx4 v8, v[196:199], s[34:35] offset:1024 sc1
    v_mfma_f32_16x16x32_bf16 v[112:115], v[218:221], v[104:107], 0
    v_lshl_add_u32 v244, v244, 6, v246
    s_mul_i32 s26, s23, 320
    s_add_u32 s26, s26, 12800
    v_mfma_f32_16x16x32_bf16 v[116:119], v[222:225], v[104:107], 0
    v_lshl_add_u32 v248, v1, 2, s26
    v_lshl_add_u32 v249, v207, 2, s26
    s_lshl_b32 s80, s21, 10
    v_mfma_f32_16x16x32_bf16 v[120:123], v[226:229], v[104:107], 0
    s_xor_b32 s81, s80, 1024
    s_xor_b32 s82, s80, 2048
    s_xor_b32 s83, s80, 3072
    s_waitcnt lgkmcnt(5)
    v_mfma_f32_16x16x32_bf16 v[16:19], a[156:159], v[76:79], v[16:19]
    ds_read_b128 v[100:103], v230 offset:896
    s_mul_i32 s26, s21, 3
    s_add_u32 s26, s26, 1
    s_lshr_b32 s26, s26, 1
    global_store_dwordx4 v8, v[196:199], s[34:35] offset:2048 sc1
    v_mfma_f32_16x16x32_bf16 v[20:23], a[188:191], v[76:79], v[20:23]
    s_mul_i32 s27, s23, 6
    s_add_u32 s26, s26, s27
    s_lshl_b32 s26, s26, 12
    v_cvt_pk_bf16_f32 v124, v108, v109
    v_cvt_pk_bf16_f32 v125, v110, v111
    s_waitcnt lgkmcnt(5)
    v_mfma_f32_16x16x32_bf16 v[16:19], a[152:155], v[80:83], v[16:19]
    ds_read_b128 v[104:107], v230 offset:960
    s_lshr_b32 s30, s21, 1
    s_mul_i32 s31, s30, 3
    s_add_u32 s31, s31, 1
    v_cvt_pk_bf16_f32 v126, v112, v113
    v_mfma_f32_16x16x32_bf16 v[20:23], a[184:187], v[80:83], v[20:23]
    s_add_u32 s27, s27, s31
    s_lshl_b32 s27, s27, 12
    s_add_u32 s72, s80, s26
    v_cvt_pk_bf16_f32 v127, v114, v115
    v_cvt_pk_bf16_f32 v128, v116, v117
    s_waitcnt lgkmcnt(5)
    v_mfma_f32_16x16x32_bf16 v[16:19], a[148:151], v[84:87], v[16:19]
    ds_read_b128 v[76:79], v230 offset:1024
    s_add_u32 s73, s81, s26
    s_add_u32 s74, s82, s26
    s_add_u32 s75, s83, s26
    global_store_dwordx4 v8, v[196:199], s[34:35] offset:3072 sc1
    v_mfma_f32_16x16x32_bf16 v[20:23], a[180:183], v[84:87], v[20:23]
    s_add_u32 s76, s80, s27
    s_add_u32 s77, s82, s27
    v_permlane16_swap_b32 v124, v126
    v_permlane16_swap_b32 v125, v127
    s_waitcnt lgkmcnt(5)
    v_mfma_f32_16x16x32_bf16 v[16:19], a[144:147], v[88:91], v[16:19]
    ds_read_b128 v[80:83], v230 offset:1088
    v_cvt_pk_bf16_f32 v129, v118, v119
    v_mfma_f32_16x16x32_bf16 v[20:23], a[176:179], v[88:91], v[20:23]
    ds_write_b128 v235, v[124:127] offset:4592
    v_cvt_pk_bf16_f32 v130, v120, v121
    s_waitcnt lgkmcnt(6)
    v_mfma_f32_16x16x32_bf16 v[16:19], a[140:143], v[92:95], v[16:19]
    ds_read_b128 v[84:87], v230 offset:1152
    v_cvt_pk_bf16_f32 v131, v122, v123
    v_mfma_f32_16x16x32_bf16 v[20:23], a[172:175], v[92:95], v[20:23]
    v_permlane16_swap_b32 v128, v130
    v_permlane16_swap_b32 v129, v131
    s_waitcnt lgkmcnt(6)
    v_mfma_f32_16x16x32_bf16 v[16:19], a[136:139], v[96:99], v[16:19]
    ds_read_b128 v[88:91], v230 offset:1216
    v_mfma_f32_16x16x32_bf16 v[20:23], a[168:171], v[96:99], v[20:23]
    ds_write_b128 v235, v[128:131] offset:10768
    s_waitcnt lgkmcnt(7)
    v_mfma_f32_16x16x32_bf16 v[16:19], a[132:135], v[100:103], v[16:19]
    ds_read_b128 v[92:95], v230 offset:1280
    v_mfma_f32_16x16x32_bf16 v[20:23], a[164:167], v[100:103], v[20:23]
    ds_read_b64_tr_b16 v[132:133], v233 offset:0
    s_waitcnt lgkmcnt(8)
    v_mfma_f32_16x16x32_bf16 v[16:19], a[128:131], v[104:107], v[16:19]
    ds_read_b128 v[96:99], v230 offset:1344
    buffer_store_dwordx4 v[196:199], v8, s[12:15], s72 offen sc1
    v_mfma_f32_16x16x32_bf16 v[20:23], a[160:163], v[104:107], v[20:23]
    ds_read_b64_tr_b16 v[134:135], v233 offset:256
    v_mfma_f32_16x16x32_bf16 v[24:27], a[192:195], v[104:107], 0
    ds_read_b64_tr_b16 v[148:149], v231 offset:0
    v_mfma_f32_16x16x32_bf16 v[32:35], a[196:199], v[104:107], 0
    ds_read_b64_tr_b16 v[150:151], v231 offset:256
    v_mfma_f32_16x16x32_bf16 v[108:111], v[214:217], v[104:107], 0
    ds_read_b64_tr_b16 v[172:173], v232 offset:0
    buffer_store_dwordx4 v[196:199], v8, s[12:15], s73 offen sc1
    v_mfma_f32_16x16x32_bf16 v[112:115], v[218:221], v[104:107], 0
    ds_read_b64_tr_b16 v[174:175], v232 offset:256
    v_mfma_f32_16x16x32_bf16 v[116:119], v[222:225], v[104:107], 0
    v_mfma_f32_16x16x32_bf16 v[120:123], v[226:229], v[104:107], 0
    s_waitcnt lgkmcnt(13)
    v_mfma_f32_16x16x32_bf16 v[20:23], a[156:159], v[76:79], v[20:23]
    ds_read_b128 v[100:103], v230 offset:1408
    buffer_store_dwordx4 v[196:199], v8, s[12:15], s74 offen sc1
    v_mfma_f32_16x16x32_bf16 v[24:27], a[188:191], v[76:79], v[24:27]
    v_cvt_pk_bf16_f32 v124, v108, v109
    v_cvt_pk_bf16_f32 v125, v110, v111
    s_waitcnt lgkmcnt(13)
    v_mfma_f32_16x16x32_bf16 v[20:23], a[152:155], v[80:83], v[20:23]
    ds_read_b128 v[104:107], v230 offset:1472
    v_cvt_pk_bf16_f32 v126, v112, v113
    v_mfma_f32_16x16x32_bf16 v[24:27], a[184:187], v[80:83], v[24:27]
    v_cvt_pk_bf16_f32 v127, v114, v115
    v_cvt_pk_bf16_f32 v128, v116, v117
    s_waitcnt lgkmcnt(12)
    v_mfma_f32_16x16x32_bf16 v[20:23], a[148:151], v[84:87], v[20:23]
    ds_read_b128 v[76:79], v230 offset:1536
    buffer_store_dwordx4 v[196:199], v8, s[12:15], s75 offen sc1
    v_mfma_f32_16x16x32_bf16 v[24:27], a[180:183], v[84:87], v[24:27]
    v_permlane16_swap_b32 v124, v126
    v_permlane16_swap_b32 v125, v127
    s_waitcnt lgkmcnt(12)
    v_mfma_f32_16x16x32_bf16 v[20:23], a[144:147], v[88:91], v[20:23]
    ds_read_b128 v[80:83], v230 offset:1600
    v_cvt_pk_bf16_f32 v129, v118, v119
    v_mfma_f32_16x16x32_bf16 v[24:27], a[176:179], v[88:91], v[24:27]
    ds_write_b128 v235, v[124:127] offset:5104
    v_cvt_pk_bf16_f32 v130, v120, v121
    s_waitcnt lgkmcnt(12)
    v_mfma_f32_16x16x32_bf16 v[20:23], a[140:143], v[92:95], v[20:23]
    ds_read_b128 v[84:87], v230 offset:1664
    buffer_store_dwordx4 v[196:199], v8, s[12:15], s76 offen sc1
    v_mfma_f32_16x16x32_bf16 v[24:27], a[172:175], v[92:95], v[24:27]
    v_cvt_pk_bf16_f32 v131, v122, v123
    v_permlane16_swap_b32 v128, v130
    s_waitcnt lgkmcnt(11)
    v_mfma_f32_16x16x32_bf16 v[20:23], a[136:139], v[96:99], v[20:23]
    ds_read_b128 v[88:91], v230 offset:1728
    v_permlane16_swap_b32 v129, v131
    v_mfma_f32_16x16x32_bf16 v[24:27], a[168:171], v[96:99], v[24:27]
    ds_write_b128 v235, v[128:131] offset:11280
    s_waitcnt lgkmcnt(7)
    v_mfma_f32_16x16x32_bf16 v[20:23], a[132:135], v[100:103], v[20:23]
    ds_read_b128 v[92:95], v230 offset:1792
    buffer_store_dwordx4 v[196:199], v8, s[12:15], s77 offen sc1
    v_mfma_f32_16x16x32_bf16 v[24:27], a[164:167], v[100:103], v[24:27]
    ds_read_b64_tr_b16 v[136:137], v233 offset:512
    s_waitcnt lgkmcnt(8)
    v_mfma_f32_16x16x32_bf16 v[20:23], a[128:131], v[104:107], v[20:23]
    ds_read_b128 v[96:99], v230 offset:1856
    v_mfma_f32_16x16x32_bf16 v[24:27], a[160:163], v[104:107], v[24:27]
    ds_read_b64_tr_b16 v[138:139], v233 offset:768
    v_mfma_f32_16x16x32_bf16 v[28:31], a[192:195], v[104:107], v[28:31]
    ds_read_b64_tr_b16 v[152:153], v231 offset:512
    v_mfma_f32_16x16x32_bf16 v[36:39], a[196:199], v[104:107], 0
    ds_read_b64_tr_b16 v[154:155], v231 offset:768
    v_mfma_f32_16x16x32_bf16 v[108:111], v[214:217], v[104:107], 0
    ds_read_b64_tr_b16 v[176:177], v232 offset:512
    v_mfma_f32_16x16x32_bf16 v[112:115], v[218:221], v[104:107], 0
    ds_read_b64_tr_b16 v[178:179], v232 offset:768
    v_mfma_f32_16x16x32_bf16 v[116:119], v[222:225], v[104:107], 0
    v_mfma_f32_16x16x32_bf16 v[120:123], v[226:229], v[104:107], 0
    s_waitcnt lgkmcnt(13)
    v_mfma_f32_16x16x32_bf16 v[24:27], a[156:159], v[76:79], v[24:27]
    ds_read_b128 v[100:103], v230 offset:1920
    v_mfma_f32_16x16x32_bf16 v[28:31], a[188:191], v[76:79], v[28:31]
    v_cvt_pk_bf16_f32 v124, v108, v109
    v_cvt_pk_bf16_f32 v125, v110, v111
    s_waitcnt lgkmcnt(13)
    v_mfma_f32_16x16x32_bf16 v[24:27], a[152:155], v[80:83], v[24:27]
    ds_read_b128 v[104:107], v230 offset:1984
    v_cvt_pk_bf16_f32 v126, v112, v113
    v_mfma_f32_16x16x32_bf16 v[28:31], a[184:187], v[80:83], v[28:31]
    v_cvt_pk_bf16_f32 v127, v114, v115
    v_cvt_pk_bf16_f32 v128, v116, v117
    s_waitcnt lgkmcnt(12)
    v_mfma_f32_16x16x32_bf16 v[24:27], a[148:151], v[84:87], v[24:27]
    ds_read_b128 v[76:79], v230 offset:2048
    v_permlane16_swap_b32 v124, v126
    v_mfma_f32_16x16x32_bf16 v[28:31], a[180:183], v[84:87], v[28:31]
    v_permlane16_swap_b32 v125, v127
    v_cvt_pk_bf16_f32 v129, v118, v119
    s_waitcnt lgkmcnt(12)
    v_mfma_f32_16x16x32_bf16 v[24:27], a[144:147], v[88:91], v[24:27]
    ds_read_b128 v[80:83], v230 offset:2112
    v_cvt_pk_bf16_f32 v130, v120, v121
    v_mfma_f32_16x16x32_bf16 v[28:31], a[176:179], v[88:91], v[28:31]
    ds_write_b128 v235, v[124:127] offset:5616
    v_cvt_pk_bf16_f32 v131, v122, v123
    s_waitcnt lgkmcnt(12)
    v_mfma_f32_16x16x32_bf16 v[24:27], a[140:143], v[92:95], v[24:27]
    ds_read_b128 v[84:87], v230 offset:2176
    v_permlane16_swap_b32 v128, v130
    v_mfma_f32_16x16x32_bf16 v[28:31], a[172:175], v[92:95], v[28:31]
    v_permlane16_swap_b32 v129, v131
    global_load_dword v250, v251, s[68:69] sc1
    s_waitcnt lgkmcnt(11)
    v_mfma_f32_16x16x32_bf16 v[24:27], a[136:139], v[96:99], v[24:27]
    ds_read_b128 v[88:91], v230 offset:2240
    v_mfma_f32_16x16x32_bf16 v[28:31], a[168:171], v[96:99], v[28:31]
    ds_write_b128 v235, v[128:131] offset:11792
    s_waitcnt lgkmcnt(7)
    v_mfma_f32_16x16x32_bf16 v[24:27], a[132:135], v[100:103], v[24:27]
    ds_read_b128 v[92:95], v230 offset:2304
    v_mfma_f32_16x16x32_bf16 v[28:31], a[164:167], v[100:103], v[28:31]
    ds_read_b64_tr_b16 v[140:141], v233 offset:1024
    s_waitcnt lgkmcnt(8)
    v_mfma_f32_16x16x32_bf16 v[24:27], a[128:131], v[104:107], v[24:27]
    ds_read_b128 v[96:99], v230 offset:2368
    v_mfma_f32_16x16x32_bf16 v[28:31], a[160:163], v[104:107], v[28:31]
    ds_read_b64_tr_b16 v[142:143], v233 offset:1280
    v_mfma_f32_16x16x32_bf16 v[32:35], a[192:195], v[104:107], v[32:35]
    ds_read_b64_tr_b16 v[156:157], v231 offset:1024
    v_mfma_f32_16x16x32_bf16 v[40:43], a[196:199], v[104:107], 0
    ds_read_b64_tr_b16 v[158:159], v231 offset:1280
    v_mfma_f32_16x16x32_bf16 v[108:111], v[214:217], v[104:107], 0
    ds_read_b64_tr_b16 v[180:181], v232 offset:1024
    v_mfma_f32_16x16x32_bf16 v[112:115], v[218:221], v[104:107], 0
    ds_read_b64_tr_b16 v[182:183], v232 offset:1280
    v_mfma_f32_16x16x32_bf16 v[116:119], v[222:225], v[104:107], 0
    v_mfma_f32_16x16x32_bf16 v[120:123], v[226:229], v[104:107], 0
    s_waitcnt lgkmcnt(13)
    v_mfma_f32_16x16x32_bf16 v[28:31], a[156:159], v[76:79], v[28:31]
    ds_read_b128 v[100:103], v230 offset:2432
    s_waitcnt vmcnt(10)
    s_barrier
    v_mfma_f32_16x16x32_bf16 v[32:35], a[188:191], v[76:79], v[32:35]
    v_cvt_pk_bf16_f32 v124, v108, v109
    v_cvt_pk_bf16_f32 v125, v110, v111
    s_waitcnt lgkmcnt(13)
    v_mfma_f32_16x16x32_bf16 v[28:31], a[152:155], v[80:83], v[28:31]
    ds_read_b128 v[104:107], v230 offset:2496
    v_cvt_pk_bf16_f32 v126, v112, v113
    v_mfma_f32_16x16x32_bf16 v[32:35], a[184:187], v[80:83], v[32:35]
    v_cvt_pk_bf16_f32 v127, v114, v115
    v_cvt_pk_bf16_f32 v128, v116, v117
    s_waitcnt lgkmcnt(12)
    v_mfma_f32_16x16x32_bf16 v[28:31], a[148:151], v[84:87], v[28:31]
    ds_read_b128 v[76:79], v230 offset:2560
    v_permlane16_swap_b32 v124, v126
    v_mfma_f32_16x16x32_bf16 v[32:35], a[180:183], v[84:87], v[32:35]
    ds_read_b128 v[44:47], v234 offset:0
    v_permlane16_swap_b32 v125, v127
    s_waitcnt lgkmcnt(13)
    v_mfma_f32_16x16x32_bf16 v[28:31], a[144:147], v[88:91], v[28:31]
    ds_read_b128 v[80:83], v230 offset:2624
    v_cvt_pk_bf16_f32 v129, v118, v119
    v_mfma_f32_16x16x32_bf16 v[32:35], a[176:179], v[88:91], v[32:35]
    ds_write_b128 v235, v[124:127] offset:6128
    v_cvt_pk_bf16_f32 v130, v120, v121
    s_waitcnt lgkmcnt(13)
    v_mfma_f32_16x16x32_bf16 v[28:31], a[140:143], v[92:95], v[28:31]
    ds_read_b128 v[84:87], v230 offset:2688
    v_cvt_pk_bf16_f32 v131, v122, v123
    v_mfma_f32_16x16x32_bf16 v[32:35], a[172:175], v[92:95], v[32:35]
    v_permlane16_swap_b32 v128, v130
    v_permlane16_swap_b32 v129, v131
    s_waitcnt lgkmcnt(12)
    v_mfma_f32_16x16x32_bf16 v[28:31], a[136:139], v[96:99], v[28:31]
    ds_read_b128 v[88:91], v230 offset:2752
    v_mfma_f32_16x16x32_bf16 v[32:35], a[168:171], v[96:99], v[32:35]
    ds_write_b128 v235, v[128:131] offset:12304
    s_waitcnt lgkmcnt(8)
    v_mfma_f32_16x16x32_bf16 v[28:31], a[132:135], v[100:103], v[28:31]
    ds_read_b128 v[92:95], v230 offset:2816
    v_mfma_f32_16x16x32_bf16 v[32:35], a[164:167], v[100:103], v[32:35]
    ds_read_b64_tr_b16 v[144:145], v233 offset:1536
    s_waitcnt lgkmcnt(9)
    v_mfma_f32_16x16x32_bf16 v[28:31], a[128:131], v[104:107], v[28:31]
    ds_read_b128 v[96:99], v230 offset:2880
    v_mfma_f32_16x16x32_bf16 v[32:35], a[160:163], v[104:107], v[32:35]
    ds_read_b64_tr_b16 v[146:147], v233 offset:1792
    v_mfma_f32_16x16x32_bf16 v[36:39], a[192:195], v[104:107], v[36:39]
    ds_read_b64_tr_b16 v[160:161], v231 offset:1536
    v_mfma_f32_16x16x32_bf16 v[108:111], v[214:217], v[104:107], 0
    ds_read_b64_tr_b16 v[162:163], v231 offset:1792
    s_waitcnt vmcnt(0)
    v_cmp_gt_u32 vcc, 1, v250
    s_nop 0
    s_cmp_eq_u64 vcc, 0
    s_cselect_b32 s6, 61440, 0
    v_mfma_f32_16x16x32_bf16 v[112:115], v[218:221], v[104:107], 0
    ds_read_b64_tr_b16 v[184:185], v232 offset:1536
    s_waitcnt lgkmcnt(13)
    v_mfma_f32_16x16x32_bf16 v[32:35], a[156:159], v[76:79], v[32:35]
    ds_read_b128 v[100:103], v230 offset:2944
    s_mov_b32 s28, 0
    buffer_load_dwordx4 a[0:3], v8, s[4:7], s28 offen offset:0 sc1
    v_mfma_f32_16x16x32_bf16 v[36:39], a[188:191], v[76:79], v[36:39]
    ds_read_b64_tr_b16 v[186:187], v232 offset:1792
    s_waitcnt lgkmcnt(13)
    v_mfma_f32_16x16x32_bf16 v[32:35], a[152:155], v[80:83], v[32:35]
    ds_read_b128 v[104:107], v230 offset:3008
    v_mfma_f32_16x16x32_bf16 v[36:39], a[184:187], v[80:83], v[36:39]
    ds_read_b128 v[48:51], v234 offset:2048
    v_cvt_pk_bf16_f32 v124, v108, v109
    s_waitcnt lgkmcnt(13)
    v_mfma_f32_16x16x32_bf16 v[32:35], a[148:151], v[84:87], v[32:35]
    ds_read_b128 v[76:79], v230 offset:3072
    v_cvt_pk_bf16_f32 v125, v110, v111
    v_mfma_f32_16x16x32_bf16 v[36:39], a[180:183], v[84:87], v[36:39]
    ds_read_b128 v[52:55], v234 offset:4096
    v_cvt_pk_bf16_f32 v126, v112, v113
    s_waitcnt lgkmcnt(14)
    v_mfma_f32_16x16x32_bf16 v[32:35], a[144:147], v[88:91], v[32:35]
    ds_read_b128 v[80:83], v230 offset:3136
    v_cvt_pk_bf16_f32 v127, v114, v115
    v_mfma_f32_16x16x32_bf16 v[36:39], a[176:179], v[88:91], v[36:39]
    v_permlane16_swap_b32 v124, v126
    v_permlane16_swap_b32 v125, v127
    s_waitcnt lgkmcnt(13)
    v_mfma_f32_16x16x32_bf16 v[32:35], a[140:143], v[92:95], v[32:35]
    ds_read_b128 v[84:87], v230 offset:3200
    buffer_load_dwordx4 a[4:7], v8, s[4:7], s28 offen offset:1024 sc1
    v_mfma_f32_16x16x32_bf16 v[36:39], a[172:175], v[92:95], v[36:39]
    ds_write_b128 v235, v[124:127] offset:6640
    buffer_load_dwordx4 a[8:11], v8, s[4:7], s28 offen offset:2048 sc1
    s_waitcnt lgkmcnt(13)
    v_mfma_f32_16x16x32_bf16 v[32:35], a[136:139], v[96:99], v[32:35]
    ds_read_b128 v[88:91], v230 offset:3264
    v_mfma_f32_16x16x32_bf16 v[36:39], a[168:171], v[96:99], v[36:39]
    ds_read_b64_tr_b16 v[164:165], v231 offset:2048
    s_waitcnt lgkmcnt(10)
    v_mfma_f32_16x16x32_bf16 v[32:35], a[132:135], v[100:103], v[32:35]
    ds_read_b128 v[92:95], v230 offset:3328
    buffer_load_dwordx4 a[12:15], v8, s[4:7], s28 offen offset:3072 sc1
    v_mfma_f32_16x16x32_bf16 v[36:39], a[164:167], v[100:103], v[36:39]
    ds_read_b64_tr_b16 v[166:167], v231 offset:2304
    s_waitcnt lgkmcnt(10)
    v_mfma_f32_16x16x32_bf16 v[32:35], a[128:131], v[104:107], v[32:35]
    ds_read_b128 v[96:99], v230 offset:3392
    v_mfma_f32_16x16x32_bf16 v[36:39], a[160:163], v[104:107], v[36:39]
    ds_read_b64_tr_b16 v[188:189], v232 offset:2048
    v_mfma_f32_16x16x32_bf16 v[40:43], a[192:195], v[104:107], v[40:43]
    ds_read_b64_tr_b16 v[190:191], v232 offset:2304
    v_mfma_f32_16x16x32_bf16 v[108:111], v[214:217], v[104:107], 0
    ds_read_b128 v[56:59], v234 offset:6144
    s_mov_b32 s28, 4096
    buffer_load_dwordx4 a[16:19], v8, s[4:7], s28 offen offset:0 sc1
    v_mfma_f32_16x16x32_bf16 v[112:115], v[218:221], v[104:107], 0
    ds_read_b128 v[60:63], v234 offset:8192
    s_waitcnt lgkmcnt(13)
    v_mfma_f32_16x16x32_bf16 v[36:39], a[156:159], v[76:79], v[36:39]
    ds_read_b128 v[100:103], v230 offset:3456
    v_mfma_f32_16x16x32_bf16 v[40:43], a[188:191], v[76:79], v[40:43]
    s_waitcnt lgkmcnt(12)
    v_mfma_f32_16x16x32_bf16 v[36:39], a[152:155], v[80:83], v[36:39]
    ds_read_b128 v[104:107], v230 offset:3520
    buffer_load_dwordx4 a[20:23], v8, s[4:7], s28 offen offset:1024 sc1
    v_mfma_f32_16x16x32_bf16 v[40:43], a[184:187], v[80:83], v[40:43]
    v_cvt_pk_bf16_f32 v124, v108, v109
    v_cvt_pk_bf16_f32 v125, v110, v111
    s_waitcnt lgkmcnt(12)
    v_mfma_f32_16x16x32_bf16 v[36:39], a[148:151], v[84:87], v[36:39]
    ds_read_b128 v[76:79], v230 offset:3584
    v_cvt_pk_bf16_f32 v126, v112, v113
    v_mfma_f32_16x16x32_bf16 v[40:43], a[180:183], v[84:87], v[40:43]
    v_cvt_pk_bf16_f32 v127, v114, v115
    s_waitcnt lgkmcnt(11)
    v_mfma_f32_16x16x32_bf16 v[36:39], a[144:147], v[88:91], v[36:39]
    ds_read_b128 v[80:83], v230 offset:3648
    v_permlane16_swap_b32 v124, v126
    v_mfma_f32_16x16x32_bf16 v[40:43], a[176:179], v[88:91], v[40:43]
    v_permlane16_swap_b32 v125, v127
    buffer_load_dwordx4 a[24:27], v8, s[4:7], s28 offen offset:2048 sc1
    s_waitcnt lgkmcnt(10)
    v_mfma_f32_16x16x32_bf16 v[36:39], a[140:143], v[92:95], v[36:39]
    ds_read_b128 v[84:87], v230 offset:3712
    v_mfma_f32_16x16x32_bf16 v[40:43], a[172:175], v[92:95], v[40:43]
    ds_write_b128 v235, v[124:127] offset:7152
    s_waitcnt lgkmcnt(10)
    v_mfma_f32_16x16x32_bf16 v[36:39], a[136:139], v[96:99], v[36:39]
    ds_read_b128 v[88:91], v230 offset:3776
    v_mfma_f32_16x16x32_bf16 v[40:43], a[168:171], v[96:99], v[40:43]
    ds_read_b64_tr_b16 v[168:169], v231 offset:2560
    buffer_load_dwordx4 a[28:31], v8, s[4:7], s28 offen offset:3072 sc1
    s_waitcnt lgkmcnt(7)
    v_mfma_f32_16x16x32_bf16 v[36:39], a[132:135], v[100:103], v[36:39]
    ds_read_b128 v[92:95], v230 offset:3840
    v_mfma_f32_16x16x32_bf16 v[40:43], a[164:167], v[100:103], v[40:43]
    ds_read_b64_tr_b16 v[170:171], v231 offset:2816
    s_waitcnt lgkmcnt(8)
    v_mfma_f32_16x16x32_bf16 v[36:39], a[128:131], v[104:107], v[36:39]
    ds_read_b128 v[96:99], v230 offset:3904
    v_mfma_f32_16x16x32_bf16 v[40:43], a[160:163], v[104:107], v[40:43]
    ds_read_b64_tr_b16 v[192:193], v232 offset:2560
    s_mov_b32 s28, 8192
    buffer_load_dwordx4 a[32:35], v8, s[4:7], s28 offen offset:0 sc1
    s_waitcnt lgkmcnt(9)
    v_mfma_f32_16x16x32_bf16 v[40:43], a[156:159], v[76:79], v[40:43]
    ds_read_b128 v[100:103], v230 offset:3968
    s_waitcnt lgkmcnt(9)
    v_mfma_f32_16x16x32_bf16 v[40:43], a[152:155], v[80:83], v[40:43]
    ds_read_b128 v[104:107], v230 offset:4032
    s_waitcnt lgkmcnt(9)
    v_mfma_f32_16x16x32_bf16 v[40:43], a[148:151], v[84:87], v[40:43]
    ds_read_b64_tr_b16 v[194:195], v232 offset:2816
    s_waitcnt lgkmcnt(8)
    v_mfma_f32_16x16x32_bf16 v[40:43], a[144:147], v[88:91], v[40:43]
    ds_read_b128 v[64:67], v234 offset:10240
    buffer_load_dwordx4 a[36:39], v8, s[4:7], s28 offen offset:1024 sc1
    s_waitcnt lgkmcnt(7)
    v_mfma_f32_16x16x32_bf16 v[40:43], a[140:143], v[92:95], v[40:43]
    ds_read_b128 v[68:71], v234 offset:12288
    s_waitcnt lgkmcnt(6)
    v_mfma_f32_16x16x32_bf16 v[40:43], a[136:139], v[96:99], v[40:43]
    ds_read_b128 v[72:75], v234 offset:14336
    s_waitcnt lgkmcnt(5)
    v_mfma_f32_16x16x32_bf16 v[40:43], a[132:135], v[100:103], v[40:43]
    ds_read_b128 v[202:205], v252 offset:0
    s_waitcnt lgkmcnt(5)
    v_mfma_f32_16x16x32_bf16 v[40:43], a[128:131], v[104:107], v[40:43]
    ds_read_b128 v[206:209], v252 offset:1024
    v_mfma_f32_16x16x32_bf16 v[76:79], v[210:213], v[44:47], 0
    ds_read_b128 v[92:95], v252 offset:2048
    buffer_load_dwordx4 a[40:43], v8, s[4:7], s28 offen offset:2048 sc1
    v_mfma_f32_16x16x32_bf16 v[80:83], v[210:213], v[48:51], 0
    ds_read_b128 v[96:99], v252 offset:3072
    v_mfma_f32_16x16x32_bf16 v[84:87], v[210:213], v[52:55], 0
    ds_read_b128 v[100:103], v252 offset:4096
    v_mfma_f32_16x16x32_bf16 v[20:23], v[148:151], a[200:203], v[20:23]
    ds_read_b128 v[104:107], v252 offset:5120
    v_mfma_f32_16x16x32_bf16 v[20:23], v[172:175], a[212:215], v[20:23]
    buffer_load_dwordx4 a[44:47], v8, s[4:7], s28 offen offset:3072 sc1
    s_waitcnt lgkmcnt(5)
    v_fma_f32 v76, v76, v202, v203
    v_mfma_f32_16x16x32_bf16 v[88:91], v[210:213], v[56:59], 0
    v_fma_f32 v77, v77, v204, v205
    s_waitcnt lgkmcnt(4)
    v_fma_f32 v78, v78, v206, v207
    v_mfma_f32_16x16x32_bf16 v[24:27], v[152:155], a[200:203], v[24:27]
    v_fma_f32 v79, v79, v208, v209
    v_fma_f32 v12, v12, s70, v76
    v_mfma_f32_16x16x32_bf16 v[24:27], v[148:151], a[204:207], v[24:27]
    v_fma_f32 v13, v13, s70, v77
    v_fma_f32 v14, v14, s70, v78
    v_mfma_f32_16x16x32_bf16 v[24:27], v[176:179], a[212:215], v[24:27]
    s_mov_b32 s28, 12288
    buffer_load_dwordx4 a[48:51], v8, s[4:7], s28 offen offset:0 sc1
    v_fma_f32 v15, v15, s70, v79
    v_mfma_f32_16x16x32_bf16 v[24:27], v[172:175], a[216:219], v[24:27]
    ds_read_b128 v[202:205], v252 offset:6144
    v_cvt_pk_bf16_f32 v108, v12, v13
    v_mfma_f32_16x16x32_bf16 v[76:79], v[210:213], v[60:63], 0
    ds_read_b128 v[206:209], v252 offset:7168
    v_cvt_pk_bf16_f32 v109, v14, v15
    v_mfma_f32_16x16x32_bf16 v[28:31], v[132:135], a[224:227], v[28:31]
    s_waitcnt lgkmcnt(5)
    v_fma_f32 v80, v80, v92, v93
    v_fma_f32 v81, v81, v94, v95
    v_mfma_f32_16x16x32_bf16 v[28:31], v[156:159], a[200:203], v[28:31]
    buffer_load_dwordx4 a[52:55], v8, s[4:7], s28 offen offset:1024 sc1
    s_waitcnt lgkmcnt(4)
    v_fma_f32 v82, v82, v96, v97
    v_mfma_f32_16x16x32_bf16 v[28:31], v[152:155], a[204:207], v[28:31]
    v_fma_f32 v83, v83, v98, v99
    v_fma_f32 v16, v16, s70, v80
    v_mfma_f32_16x16x32_bf16 v[28:31], v[148:151], a[208:211], v[28:31]
    v_fma_f32 v17, v17, s70, v81
    v_fma_f32 v18, v18, s70, v82
    v_mfma_f32_16x16x32_bf16 v[28:31], v[180:183], a[212:215], v[28:31]
    v_fma_f32 v19, v19, s70, v83
    v_cvt_pk_bf16_f32 v110, v16, v17
    v_mfma_f32_16x16x32_bf16 v[28:31], v[176:179], a[216:219], v[28:31]
    ds_read_b128 v[92:95], v252 offset:8192
    v_cvt_pk_bf16_f32 v111, v18, v19
    v_mfma_f32_16x16x32_bf16 v[28:31], v[172:175], a[220:223], v[28:31]
    ds_read_b128 v[96:99], v252 offset:9216
    buffer_load_dwordx4 a[56:59], v8, s[4:7], s28 offen offset:2048 sc1
    v_mfma_f32_16x16x32_bf16 v[80:83], v[210:213], v[64:67], 0
    global_store_dwordx4 v8, v[108:111], s[34:35] offset:0 sc1
    s_waitcnt lgkmcnt(5)
    v_fma_f32 v84, v84, v100, v101
    v_mfma_f32_16x16x32_bf16 v[32:35], v[136:139], a[224:227], v[32:35]
    v_fma_f32 v85, v85, v102, v103
    s_waitcnt lgkmcnt(4)
    v_fma_f32 v86, v86, v104, v105
    v_mfma_f32_16x16x32_bf16 v[32:35], v[132:135], a[228:231], v[32:35]
    v_fma_f32 v87, v87, v106, v107
    v_fma_f32 v20, v20, s70, v84
    v_mfma_f32_16x16x32_bf16 v[32:35], v[160:163], a[200:203], v[32:35]
    buffer_load_dwordx4 a[60:63], v8, s[4:7], s28 offen offset:3072 sc1
    v_fma_f32 v21, v21, s70, v85
    v_mfma_f32_16x16x32_bf16 v[32:35], v[156:159], a[204:207], v[32:35]
    v_fma_f32 v22, v22, s70, v86
    v_fma_f32 v23, v23, s70, v87
    v_mfma_f32_16x16x32_bf16 v[32:35], v[152:155], a[208:211], v[32:35]
    ds_read_b128 v[100:103], v252 offset:10240
    v_cvt_pk_bf16_f32 v112, v20, v21
    v_mfma_f32_16x16x32_bf16 v[32:35], v[184:187], a[212:215], v[32:35]
    ds_read_b128 v[104:107], v252 offset:11264
    v_cvt_pk_bf16_f32 v113, v22, v23
    v_mfma_f32_16x16x32_bf16 v[32:35], v[180:183], a[216:219], v[32:35]
    s_mov_b32 s28, 16384
    buffer_load_dwordx4 a[64:67], v8, s[4:7], s28 offen offset:0 sc1
    s_waitcnt lgkmcnt(5)
    v_fma_f32 v88, v88, v202, v203
    v_mfma_f32_16x16x32_bf16 v[32:35], v[176:179], a[220:223], v[32:35]
    v_fma_f32 v89, v89, v204, v205
    s_waitcnt lgkmcnt(4)
    v_fma_f32 v90, v90, v206, v207
    v_mfma_f32_16x16x32_bf16 v[84:87], v[210:213], v[68:71], 0
    v_fma_f32 v91, v91, v208, v209
    v_fma_f32 v24, v24, s70, v88
    v_mfma_f32_16x16x32_bf16 v[36:39], v[140:143], a[224:227], v[36:39]
    v_fma_f32 v25, v25, s70, v89
    v_fma_f32 v26, v26, s70, v90
    v_mfma_f32_16x16x32_bf16 v[36:39], v[136:139], a[228:231], v[36:39]
    v_fma_f32 v27, v27, s70, v91
    v_cvt_pk_bf16_f32 v114, v24, v25
    v_mfma_f32_16x16x32_bf16 v[36:39], v[132:135], a[232:235], v[36:39]
    ds_read_b128 v[202:205], v252 offset:12288
    buffer_load_dwordx4 a[68:71], v8, s[4:7], s28 offen offset:1024 sc1
    v_mfma_f32_16x16x32_bf16 v[36:39], v[164:167], a[200:203], v[36:39]
    ds_read_b128 v[206:209], v252 offset:13312
    v_cvt_pk_bf16_f32 v115, v26, v27
    v_mfma_f32_16x16x32_bf16 v[36:39], v[160:163], a[204:207], v[36:39]
    global_store_dwordx4 v8, v[112:115], s[34:35] offset:1024 sc1
    s_waitcnt lgkmcnt(5)
    v_fma_f32 v76, v76, v92, v93
    v_mfma_f32_16x16x32_bf16 v[36:39], v[156:159], a[208:211], v[36:39]
    v_fma_f32 v77, v77, v94, v95
    s_waitcnt lgkmcnt(4)
    v_fma_f32 v78, v78, v96, v97
    v_mfma_f32_16x16x32_bf16 v[36:39], v[188:191], a[212:215], v[36:39]
    buffer_load_dwordx4 a[72:75], v8, s[4:7], s28 offen offset:2048 sc1
    v_fma_f32 v79, v79, v98, v99
    v_mfma_f32_16x16x32_bf16 v[36:39], v[184:187], a[216:219], v[36:39]
    v_fma_f32 v28, v28, s70, v76
    v_fma_f32 v29, v29, s70, v77
    v_mfma_f32_16x16x32_bf16 v[36:39], v[180:183], a[220:223], v[36:39]
    v_fma_f32 v30, v30, s70, v78
    v_fma_f32 v31, v31, s70, v79
    v_mfma_f32_16x16x32_bf16 v[88:91], v[210:213], v[72:75], 0
    ds_read_b128 v[92:95], v252 offset:14336
    v_cvt_pk_bf16_f32 v116, v28, v29
    v_mfma_f32_16x16x32_bf16 v[40:43], v[144:147], a[224:227], v[40:43]
    ds_read_b128 v[96:99], v252 offset:15360
    buffer_load_dwordx4 a[76:79], v8, s[4:7], s28 offen offset:3072 sc1
    v_mfma_f32_16x16x32_bf16 v[40:43], v[140:143], a[228:231], v[40:43]
    v_cvt_pk_bf16_f32 v117, v30, v31
    s_waitcnt lgkmcnt(5)
    v_fma_f32 v80, v80, v100, v101
    v_mfma_f32_16x16x32_bf16 v[40:43], v[136:139], a[232:235], v[40:43]
    v_fma_f32 v81, v81, v102, v103
    s_waitcnt lgkmcnt(4)
    v_fma_f32 v82, v82, v104, v105
    v_mfma_f32_16x16x32_bf16 v[40:43], v[132:135], a[236:239], v[40:43]
    v_fma_f32 v83, v83, v106, v107
    v_fma_f32 v32, v32, s70, v80
    v_mfma_f32_16x16x32_bf16 v[40:43], v[168:171], a[200:203], v[40:43]
    v_fma_f32 v33, v33, s70, v81
    v_fma_f32 v34, v34, s70, v82
    v_mfma_f32_16x16x32_bf16 v[40:43], v[164:167], a[204:207], v[40:43]
    v_fma_f32 v35, v35, s70, v83
    v_cvt_pk_bf16_f32 v118, v32, v33
    v_mfma_f32_16x16x32_bf16 v[40:43], v[160:163], a[208:211], v[40:43]
    v_cvt_pk_bf16_f32 v119, v34, v35
    global_store_dwordx4 v8, v[116:119], s[34:35] offset:2048 sc1
    v_mfma_f32_16x16x32_bf16 v[40:43], v[192:195], a[212:215], v[40:43]
    s_waitcnt lgkmcnt(3)
    v_fma_f32 v84, v84, v202, v203
    v_fma_f32 v85, v85, v204, v205
    v_mfma_f32_16x16x32_bf16 v[40:43], v[188:191], a[216:219], v[40:43]
    s_waitcnt lgkmcnt(2)
    v_fma_f32 v86, v86, v206, v207
    v_fma_f32 v87, v87, v208, v209
    v_mfma_f32_16x16x32_bf16 v[40:43], v[184:187], a[220:223], v[40:43]
    v_fma_f32 v36, v36, s70, v84
    v_fma_f32 v37, v37, s70, v85
    v_fma_f32 v38, v38, s70, v86
    v_fma_f32 v39, v39, s70, v87
    v_cvt_pk_bf16_f32 v120, v36, v37
    v_cvt_pk_bf16_f32 v121, v38, v39
    s_waitcnt lgkmcnt(1)
    v_fma_f32 v88, v88, v92, v93
    v_fma_f32 v89, v89, v94, v95
    s_waitcnt lgkmcnt(0)
    v_fma_f32 v90, v90, v96, v97
    v_fma_f32 v91, v91, v98, v99
    v_fma_f32 v40, v40, s70, v88
    v_fma_f32 v41, v41, s70, v89
    v_fma_f32 v42, v42, s70, v90
    v_fma_f32 v43, v43, s70, v91
    v_cvt_pk_bf16_f32 v122, v40, v41
    v_cvt_pk_bf16_f32 v123, v42, v43
    global_store_dwordx4 v8, v[120:123], s[34:35] offset:3072 sc1
    s_branch LF_mlp
LF_cmod:
    s_waitcnt vmcnt(0) lgkmcnt(0)
    s_barrier
    ds_read_b64_tr_b16 v[184:185], v159 offset:0
    ds_read_b64_tr_b16 v[186:187], v159 offset:512
    ds_read_b64_tr_b16 v[188:189], v159 offset:4096
    ds_read_b64_tr_b16 v[190:191], v159 offset:4608
    ds_read_b64_tr_b16 v[192:193], v159 offset:8192
    ds_read_b64_tr_b16 v[194:195], v159 offset:8704
    ds_read_b64_tr_b16 v[196:197], v159 offset:12288
    ds_read_b64_tr_b16 v[198:199], v159 offset:12800
    ds_read_b64_tr_b16 v[200:201], v159 offset:16384
    ds_read_b64_tr_b16 v[202:203], v159 offset:16896
    s_waitcnt lgkmcnt(8)
    v_mfma_f32_16x16x32_bf16 v[204:207], v[164:167], v[184:187], 0
    s_waitcnt lgkmcnt(6)
    v_mfma_f32_16x16x32_bf16 v[204:207], v[168:171], v[188:191], v[204:207]
    s_waitcnt lgkmcnt(4)
    v_mfma_f32_16x16x32_bf16 v[204:207], v[172:175], v[192:195], v[204:207]
    s_waitcnt lgkmcnt(2)
    v_mfma_f32_16x16x32_bf16 v[204:207], v[176:179], v[196:199], v[204:207]
    s_waitcnt lgkmcnt(0)
    v_mfma_f32_16x16x32_bf16 v[204:207], v[180:183], v[200:203], v[204:207]
    s_mov_b64 exec, 0xffff
    s_nop 6
    global_store_dword v158, v204, s[68:69] sc1
    s_mov_b64 exec, -1
    global_load_dword v122, v123, s[66:67] sc1
    s_branch LF_noarr1
LF_side:
    s_sub_u32 s20, s2, 160
    s_mul_i32 s33, s21, 25600
    s_add_u32 s34, s33, 12800
    v_bfe_u32 v11, v1, 2, 2
    v_lshrrev_b32 v12, 4, v1
    v_and_b32 v10, 3, v1
    v_and_b32 v13, 15, v1
    s_mul_i32 s31, s21, 96
    s_add_u32 s31, s31, s20
    s_cmp_lt_u32 s31, 256
    s_waitcnt lgkmcnt(0)
    s_cmp_lt_u32 s31, 256
    s_cbranch_scc0 LF_sa_mod
    v_lshrrev_b32 v2, 3, v1
    v_and_b32 v3, 7, v1
    v_lshlrev_b32 v3, 4, v3
    v_mul_u32_u24 v7, 1280, v2
    v_add_u32 v7, v7, v3
    s_mul_i32 s24, s31, 10240
    v_add_u32 v7, s24, v7
    global_load_dwordx4 v[164:167], v7, s[36:37] offset:0
    global_load_dwordx4 v[168:171], v7, s[36:37] offset:128
    global_load_dwordx4 v[172:175], v7, s[36:37] offset:256
    global_load_dwordx4 v[176:179], v7, s[36:37] offset:384
    global_load_dwordx4 v[180:183], v7, s[36:37] offset:512
    global_load_dwordx4 v[184:187], v7, s[36:37] offset:640
    global_load_dwordx4 v[188:191], v7, s[36:37] offset:768
    global_load_dwordx4 v[192:195], v7, s[36:37] offset:896
    global_load_dwordx4 v[196:199], v7, s[36:37] offset:1024
    global_load_dwordx4 v[200:203], v7, s[36:37] offset:1152
    v_mul_u32_u24 v7, 1344, v2
    v_add3_u32 v7, v7, v3, s33
    v_mul_u32_u24 v9, 1344, v11
    v_lshl_add_u32 v9, v12, 5, v9
    v_lshl_add_u32 v9, v10, 3, v9
    v_add_u32 v9, s33, v9
    v_lshrrev_b32 v2, 2, v1
    v_lshlrev_b32 v2, 14, v2
    v_lshl_add_u32 v2, v10, 4, v2
    s_lshl_b32 s24, s31, 6
    s_add_u32 s24, s24, 1048576
    v_add_u32 v2, s24, v2
    s_lshr_b32 s24, s31, 5
    s_lshl_b32 s24, s24, 11
    s_bfe_u32 s25, s31, 0x40001
    s_lshl_b32 s25, s25, 4
    s_add_u32 s24, s24, s25
    s_and_b32 s25, s31, 1
    s_lshl_b32 s25, s25, 9
    s_add_u32 s24, s24, s25
    s_add_u32 s24, s24, 262144
    v_lshrrev_b32 v3, 5, v1
    v_lshlrev_b32 v3, 8, v3
    v_bfe_u32 v14, v1, 4, 1
    v_lshl_add_u32 v3, v14, 10, v3
    v_bfe_u32 v14, v1, 3, 1
    v_lshl_add_u32 v3, v14, 3, v3
    v_add_u32 v3, s24, v3
    s_mov_b32 s24, 0x3f803f80
    v_mov_b32 v123, 0
    v_mov_b32 v140, 0
    v_mov_b32 v141, 0
    v_mov_b32 v142, 0
    v_mov_b32 v143, 0
    s_waitcnt vmcnt(9)
    ds_write_b128 v7, v[164:167] offset:0
    v_dot2c_f32_bf16 v140, s24, v164
    v_dot2c_f32_bf16 v141, v164, v164
    v_dot2c_f32_bf16 v142, s24, v165
    v_dot2c_f32_bf16 v143, v165, v165
    v_dot2c_f32_bf16 v140, s24, v166
    v_dot2c_f32_bf16 v141, v166, v166
    v_dot2c_f32_bf16 v142, s24, v167
    v_dot2c_f32_bf16 v143, v167, v167
    s_waitcnt vmcnt(8)
    ds_write_b128 v7, v[168:171] offset:128
    v_dot2c_f32_bf16 v140, s24, v168
    v_dot2c_f32_bf16 v141, v168, v168
    v_dot2c_f32_bf16 v142, s24, v169
    v_dot2c_f32_bf16 v143, v169, v169
    v_dot2c_f32_bf16 v140, s24, v170
    v_dot2c_f32_bf16 v141, v170, v170
    v_dot2c_f32_bf16 v142, s24, v171
    v_dot2c_f32_bf16 v143, v171, v171
    s_waitcnt vmcnt(7)
    ds_write_b128 v7, v[172:175] offset:256
    v_dot2c_f32_bf16 v140, s24, v172
    v_dot2c_f32_bf16 v141, v172, v172
    v_dot2c_f32_bf16 v142, s24, v173
    v_dot2c_f32_bf16 v143, v173, v173
    v_dot2c_f32_bf16 v140, s24, v174
    v_dot2c_f32_bf16 v141, v174, v174
    v_dot2c_f32_bf16 v142, s24, v175
    v_dot2c_f32_bf16 v143, v175, v175
    s_waitcnt vmcnt(6)
    ds_write_b128 v7, v[176:179] offset:384
    v_dot2c_f32_bf16 v140, s24, v176
    v_dot2c_f32_bf16 v141, v176, v176
    v_dot2c_f32_bf16 v142, s24, v177
    v_dot2c_f32_bf16 v143, v177, v177
    v_dot2c_f32_bf16 v140, s24, v178
    v_dot2c_f32_bf16 v141, v178, v178
    v_dot2c_f32_bf16 v142, s24, v179
    v_dot2c_f32_bf16 v143, v179, v179
    s_waitcnt vmcnt(5)
    ds_write_b128 v7, v[180:183] offset:512
    v_dot2c_f32_bf16 v140, s24, v180
    v_dot2c_f32_bf16 v141, v180, v180
    v_dot2c_f32_bf16 v142, s24, v181
    v_dot2c_f32_bf16 v143, v181, v181
    v_dot2c_f32_bf16 v140, s24, v182
    v_dot2c_f32_bf16 v141, v182, v182
    v_dot2c_f32_bf16 v142, s24, v183
    v_dot2c_f32_bf16 v143, v183, v183
    s_waitcnt vmcnt(4)
    ds_write_b128 v7, v[184:187] offset:640
    v_dot2c_f32_bf16 v140, s24, v184
    v_dot2c_f32_bf16 v141, v184, v184
    v_dot2c_f32_bf16 v142, s24, v185
    v_dot2c_f32_bf16 v143, v185, v185
    v_dot2c_f32_bf16 v140, s24, v186
    v_dot2c_f32_bf16 v141, v186, v186
    v_dot2c_f32_bf16 v142, s24, v187
    v_dot2c_f32_bf16 v143, v187, v187
    s_waitcnt vmcnt(3)
    ds_write_b128 v7, v[188:191] offset:768
    v_dot2c_f32_bf16 v140, s24, v188
    v_dot2c_f32_bf16 v141, v188, v188
    v_dot2c_f32_bf16 v142, s24, v189
    v_dot2c_f32_bf16 v143, v189, v189
    v_dot2c_f32_bf16 v140, s24, v190
    v_dot2c_f32_bf16 v141, v190, v190
    v_dot2c_f32_bf16 v142, s24, v191
    v_dot2c_f32_bf16 v143, v191, v191
    s_waitcnt vmcnt(2)
    ds_write_b128 v7, v[192:195] offset:896
    v_dot2c_f32_bf16 v140, s24, v192
    v_dot2c_f32_bf16 v141, v192, v192
    v_dot2c_f32_bf16 v142, s24, v193
    v_dot2c_f32_bf16 v143, v193, v193
    v_dot2c_f32_bf16 v140, s24, v194
    v_dot2c_f32_bf16 v141, v194, v194
    v_dot2c_f32_bf16 v142, s24, v195
    v_dot2c_f32_bf16 v143, v195, v195
    s_waitcnt vmcnt(1)
    ds_write_b128 v7, v[196:199] offset:1024
    v_dot2c_f32_bf16 v140, s24, v196
    v_dot2c_f32_bf16 v141, v196, v196
    v_dot2c_f32_bf16 v142, s24, v197
    v_dot2c_f32_bf16 v143, v197, v197
    v_dot2c_f32_bf16 v140, s24, v198
    v_dot2c_f32_bf16 v141, v198, v198
    v_dot2c_f32_bf16 v142, s24, v199
    v_dot2c_f32_bf16 v143, v199, v199
    s_waitcnt vmcnt(0)
    ds_write_b128 v7, v[200:203] offset:1152
    v_dot2c_f32_bf16 v140, s24, v200
    v_dot2c_f32_bf16 v141, v200, v200
    v_dot2c_f32_bf16 v142, s24, v201
    v_dot2c_f32_bf16 v143, v201, v201
    v_dot2c_f32_bf16 v140, s24, v202
    v_dot2c_f32_bf16 v141, v202, v202
    v_dot2c_f32_bf16 v142, s24, v203
    v_dot2c_f32_bf16 v143, v203, v203
    s_nop 2
    v_pk_add_f32 v[140:141], v[140:141], v[142:143]
    s_nop 1
    v_add_f32_dpp v140, v140, v140 quad_perm:[1,0,3,2] row_mask:0xf bank_mask:0xf
    v_add_f32_dpp v141, v141, v141 quad_perm:[1,0,3,2] row_mask:0xf bank_mask:0xf
    s_nop 0
    v_add_f32_dpp v140, v140, v140 quad_perm:[2,3,0,1] row_mask:0xf bank_mask:0xf
    v_add_f32_dpp v141, v141, v141 quad_perm:[2,3,0,1] row_mask:0xf bank_mask:0xf
    s_nop 0
    v_add_f32_dpp v140, v140, v140 row_half_mirror row_mask:0xf bank_mask:0xf
    v_add_f32_dpp v141, v141, v141 row_half_mirror row_mask:0xf bank_mask:0xf
    v_mul_f32 v140, 986500301, v140
    v_mul_f32 v141, 986500301, v141
    ds_read_b64_tr_b16 v[164:165], v9 offset:0
    ds_read_b64_tr_b16 v[166:167], v9 offset:5376
    ds_read_b64_tr_b16 v[168:169], v9 offset:128
    ds_read_b64_tr_b16 v[170:171], v9 offset:5504
    ds_read_b64_tr_b16 v[172:173], v9 offset:256
    ds_read_b64_tr_b16 v[174:175], v9 offset:5632
    ds_read_b64_tr_b16 v[176:177], v9 offset:384
    ds_read_b64_tr_b16 v[178:179], v9 offset:5760
    ds_read_b64_tr_b16 v[180:181], v9 offset:512
    ds_read_b64_tr_b16 v[182:183], v9 offset:5888
    v_fma_f32 v141, -v140, v140, v141
    v_max_f32 v141, 0, v141
    v_cvt_pk_bf16_f32 v141, v141, v140
    v_and_b32 v140, 0xffff0000, v141
    v_lshlrev_b32 v141, 16, v141
    v_add_f32 v141, 925353388, v141
    v_cvt_pk_bf16_f32 v141, v141, v141
    v_lshlrev_b32 v141, 16, v141
    v_sqrt_f32 v141, v141
    s_nop 0
    v_cvt_pk_bf16_f32 v141, v141, v141
    v_lshlrev_b32 v141, 16, v141
    v_rcp_f32 v144, v141
    v_mov_b32 v142, v141
    v_mov_b32 v143, v140
    v_mul_f32 v140, v140, v144
    s_mov_b32 exec_lo, 0x01010101
    s_mov_b32 exec_hi, 0x01010101
    global_store_dwordx2 v3, v[142:143], s[68:69] sc1
    s_mov_b64 exec, -1
    ds_read_b64_tr_b16 v[184:185], v9 offset:640
    ds_read_b64_tr_b16 v[186:187], v9 offset:6016
    ds_read_b64_tr_b16 v[188:189], v9 offset:768
    ds_read_b64_tr_b16 v[190:191], v9 offset:6144
    ds_read_b64_tr_b16 v[192:193], v9 offset:896
    ds_read_b64_tr_b16 v[194:195], v9 offset:6272
    ds_read_b64_tr_b16 v[196:197], v9 offset:1024
    ds_read_b64_tr_b16 v[198:199], v9 offset:6400
    ds_read_b64_tr_b16 v[200:201], v9 offset:1152
    ds_read_b64_tr_b16 v[202:203], v9 offset:6528
    v_readlane_b32 s70, v144, 0
    v_readlane_b32 s71, v144, 8
    v_readlane_b32 s72, v144, 16
    v_readlane_b32 s73, v144, 24
    v_readlane_b32 s74, v144, 32
    v_readlane_b32 s75, v144, 40
    v_readlane_b32 s76, v144, 48
    v_readlane_b32 s77, v144, 56
    v_readlane_b32 s78, v140, 0
    v_readlane_b32 s79, v140, 8
    v_readlane_b32 s80, v140, 16
    v_readlane_b32 s81, v140, 24
    v_readlane_b32 s82, v140, 32
    v_readlane_b32 s83, v140, 40
    v_readlane_b32 s84, v140, 48
    v_readlane_b32 s85, v140, 56
    v_mov_b32 v16, s78
    v_mov_b32 v17, s79
    v_mov_b32 v18, s80
    v_mov_b32 v19, s81
    v_mov_b32 v20, s82
    v_mov_b32 v21, s83
    v_mov_b32 v22, s84
    v_mov_b32 v23, s85
    s_waitcnt lgkmcnt(15)
    v_lshlrev_b32 v24, 16, v164
    v_and_b32 v25, 0xffff0000, v164
    v_lshlrev_b32 v26, 16, v165
    v_and_b32 v27, 0xffff0000, v165
    v_lshlrev_b32 v28, 16, v166
    v_and_b32 v29, 0xffff0000, v166
    v_lshlrev_b32 v30, 16, v167
    v_and_b32 v31, 0xffff0000, v167
    v_pk_fma_f32 v[24:25], v[24:25], s[70:71], v[16:17] neg_lo:[0,0,1] neg_hi:[0,0,1]
    v_pk_fma_f32 v[26:27], v[26:27], s[72:73], v[18:19] neg_lo:[0,0,1] neg_hi:[0,0,1]
    v_pk_fma_f32 v[28:29], v[28:29], s[74:75], v[20:21] neg_lo:[0,0,1] neg_hi:[0,0,1]
    v_pk_fma_f32 v[30:31], v[30:31], s[76:77], v[22:23] neg_lo:[0,0,1] neg_hi:[0,0,1]
    v_cvt_pk_bf16_f32 v32, v24, v25
    v_cvt_pk_bf16_f32 v33, v26, v27
    v_cvt_pk_bf16_f32 v34, v28, v29
    v_cvt_pk_bf16_f32 v35, v30, v31
    global_store_dwordx4 v2, v[32:35], s[68:69] sc1
    v_add_u32 v2, 0x40000, v2
    v_lshlrev_b32 v36, 16, v168
    v_and_b32 v37, 0xffff0000, v168
    v_lshlrev_b32 v38, 16, v169
    v_and_b32 v39, 0xffff0000, v169
    v_lshlrev_b32 v40, 16, v170
    v_and_b32 v41, 0xffff0000, v170
    v_lshlrev_b32 v42, 16, v171
    v_and_b32 v43, 0xffff0000, v171
    v_pk_fma_f32 v[36:37], v[36:37], s[70:71], v[16:17] neg_lo:[0,0,1] neg_hi:[0,0,1]
    v_pk_fma_f32 v[38:39], v[38:39], s[72:73], v[18:19] neg_lo:[0,0,1] neg_hi:[0,0,1]
    v_pk_fma_f32 v[40:41], v[40:41], s[74:75], v[20:21] neg_lo:[0,0,1] neg_hi:[0,0,1]
    v_pk_fma_f32 v[42:43], v[42:43], s[76:77], v[22:23] neg_lo:[0,0,1] neg_hi:[0,0,1]
    v_cvt_pk_bf16_f32 v44, v36, v37
    v_cvt_pk_bf16_f32 v45, v38, v39
    v_cvt_pk_bf16_f32 v46, v40, v41
    v_cvt_pk_bf16_f32 v47, v42, v43
    global_store_dwordx4 v2, v[44:47], s[68:69] sc1
    v_add_u32 v2, 0x40000, v2
    v_lshlrev_b32 v48, 16, v172
    v_and_b32 v49, 0xffff0000, v172
    v_lshlrev_b32 v50, 16, v173
    v_and_b32 v51, 0xffff0000, v173
    s_waitcnt lgkmcnt(14)
    v_lshlrev_b32 v52, 16, v174
    v_and_b32 v53, 0xffff0000, v174
    v_lshlrev_b32 v54, 16, v175
    v_and_b32 v55, 0xffff0000, v175
    v_pk_fma_f32 v[48:49], v[48:49], s[70:71], v[16:17] neg_lo:[0,0,1] neg_hi:[0,0,1]
    v_pk_fma_f32 v[50:51], v[50:51], s[72:73], v[18:19] neg_lo:[0,0,1] neg_hi:[0,0,1]
    v_pk_fma_f32 v[52:53], v[52:53], s[74:75], v[20:21] neg_lo:[0,0,1] neg_hi:[0,0,1]
    v_pk_fma_f32 v[54:55], v[54:55], s[76:77], v[22:23] neg_lo:[0,0,1] neg_hi:[0,0,1]
    v_cvt_pk_bf16_f32 v56, v48, v49
    v_cvt_pk_bf16_f32 v57, v50, v51
    v_cvt_pk_bf16_f32 v58, v52, v53
    v_cvt_pk_bf16_f32 v59, v54, v55
    global_store_dwordx4 v2, v[56:59], s[68:69] sc1
    v_add_u32 v2, 0x40000, v2
    s_waitcnt lgkmcnt(13)
    v_lshlrev_b32 v24, 16, v176
    v_and_b32 v25, 0xffff0000, v176
    v_lshlrev_b32 v26, 16, v177
    v_and_b32 v27, 0xffff0000, v177
    s_waitcnt lgkmcnt(12)
    v_lshlrev_b32 v28, 16, v178
    v_and_b32 v29, 0xffff0000, v178
    v_lshlrev_b32 v30, 16, v179
    v_and_b32 v31, 0xffff0000, v179
    v_pk_fma_f32 v[24:25], v[24:25], s[70:71], v[16:17] neg_lo:[0,0,1] neg_hi:[0,0,1]
    v_pk_fma_f32 v[26:27], v[26:27], s[72:73], v[18:19] neg_lo:[0,0,1] neg_hi:[0,0,1]
    v_pk_fma_f32 v[28:29], v[28:29], s[74:75], v[20:21] neg_lo:[0,0,1] neg_hi:[0,0,1]
    v_pk_fma_f32 v[30:31], v[30:31], s[76:77], v[22:23] neg_lo:[0,0,1] neg_hi:[0,0,1]
    v_cvt_pk_bf16_f32 v32, v24, v25
    v_cvt_pk_bf16_f32 v33, v26, v27
    v_cvt_pk_bf16_f32 v34, v28, v29
    v_cvt_pk_bf16_f32 v35, v30, v31
    global_store_dwordx4 v2, v[32:35], s[68:69] sc1
    v_add_u32 v2, 0x40000, v2
    s_waitcnt lgkmcnt(11)
    v_lshlrev_b32 v36, 16, v180
    v_and_b32 v37, 0xffff0000, v180
    v_lshlrev_b32 v38, 16, v181
    v_and_b32 v39, 0xffff0000, v181
    s_waitcnt lgkmcnt(10)
    v_lshlrev_b32 v40, 16, v182
    v_and_b32 v41, 0xffff0000, v182
    v_lshlrev_b32 v42, 16, v183
    v_and_b32 v43, 0xffff0000, v183
    v_pk_fma_f32 v[36:37], v[36:37], s[70:71], v[16:17] neg_lo:[0,0,1] neg_hi:[0,0,1]
    v_pk_fma_f32 v[38:39], v[38:39], s[72:73], v[18:19] neg_lo:[0,0,1] neg_hi:[0,0,1]
    v_pk_fma_f32 v[40:41], v[40:41], s[74:75], v[20:21] neg_lo:[0,0,1] neg_hi:[0,0,1]
    v_pk_fma_f32 v[42:43], v[42:43], s[76:77], v[22:23] neg_lo:[0,0,1] neg_hi:[0,0,1]
    v_cvt_pk_bf16_f32 v44, v36, v37
    v_cvt_pk_bf16_f32 v45, v38, v39
    v_cvt_pk_bf16_f32 v46, v40, v41
    v_cvt_pk_bf16_f32 v47, v42, v43
    global_store_dwordx4 v2, v[44:47], s[68:69] sc1
    v_add_u32 v2, 0x40000, v2
    s_waitcnt lgkmcnt(9)
    v_lshlrev_b32 v48, 16, v184
    v_and_b32 v49, 0xffff0000, v184
    v_lshlrev_b32 v50, 16, v185
    v_and_b32 v51, 0xffff0000, v185
    s_waitcnt lgkmcnt(8)
    v_lshlrev_b32 v52, 16, v186
    v_and_b32 v53, 0xffff0000, v186
    v_lshlrev_b32 v54, 16, v187
    v_and_b32 v55, 0xffff0000, v187
    v_pk_fma_f32 v[48:49], v[48:49], s[70:71], v[16:17] neg_lo:[0,0,1] neg_hi:[0,0,1]
    v_pk_fma_f32 v[50:51], v[50:51], s[72:73], v[18:19] neg_lo:[0,0,1] neg_hi:[0,0,1]
    v_pk_fma_f32 v[52:53], v[52:53], s[74:75], v[20:21] neg_lo:[0,0,1] neg_hi:[0,0,1]
    v_pk_fma_f32 v[54:55], v[54:55], s[76:77], v[22:23] neg_lo:[0,0,1] neg_hi:[0,0,1]
    v_cvt_pk_bf16_f32 v56, v48, v49
    v_cvt_pk_bf16_f32 v57, v50, v51
    v_cvt_pk_bf16_f32 v58, v52, v53
    v_cvt_pk_bf16_f32 v59, v54, v55
    global_store_dwordx4 v2, v[56:59], s[68:69] sc1
    v_add_u32 v2, 0x40000, v2
    s_waitcnt lgkmcnt(7)
    v_lshlrev_b32 v24, 16, v188
    v_and_b32 v25, 0xffff0000, v188
    v_lshlrev_b32 v26, 16, v189
    v_and_b32 v27, 0xffff0000, v189
    s_waitcnt lgkmcnt(6)
    v_lshlrev_b32 v28, 16, v190
    v_and_b32 v29, 0xffff0000, v190
    v_lshlrev_b32 v30, 16, v191
    v_and_b32 v31, 0xffff0000, v191
    v_pk_fma_f32 v[24:25], v[24:25], s[70:71], v[16:17] neg_lo:[0,0,1] neg_hi:[0,0,1]
    v_pk_fma_f32 v[26:27], v[26:27], s[72:73], v[18:19] neg_lo:[0,0,1] neg_hi:[0,0,1]
    v_pk_fma_f32 v[28:29], v[28:29], s[74:75], v[20:21] neg_lo:[0,0,1] neg_hi:[0,0,1]
    v_pk_fma_f32 v[30:31], v[30:31], s[76:77], v[22:23] neg_lo:[0,0,1] neg_hi:[0,0,1]
    v_cvt_pk_bf16_f32 v32, v24, v25
    v_cvt_pk_bf16_f32 v33, v26, v27
    v_cvt_pk_bf16_f32 v34, v28, v29
    v_cvt_pk_bf16_f32 v35, v30, v31
    global_store_dwordx4 v2, v[32:35], s[68:69] sc1
    v_add_u32 v2, 0x40000, v2
    s_waitcnt lgkmcnt(5)
    v_lshlrev_b32 v36, 16, v192
    v_and_b32 v37, 0xffff0000, v192
    v_lshlrev_b32 v38, 16, v193
    v_and_b32 v39, 0xffff0000, v193
    s_waitcnt lgkmcnt(4)
    v_lshlrev_b32 v40, 16, v194
    v_and_b32 v41, 0xffff0000, v194
    v_lshlrev_b32 v42, 16, v195
    v_and_b32 v43, 0xffff0000, v195
    v_pk_fma_f32 v[36:37], v[36:37], s[70:71], v[16:17] neg_lo:[0,0,1] neg_hi:[0,0,1]
    v_pk_fma_f32 v[38:39], v[38:39], s[72:73], v[18:19] neg_lo:[0,0,1] neg_hi:[0,0,1]
    v_pk_fma_f32 v[40:41], v[40:41], s[74:75], v[20:21] neg_lo:[0,0,1] neg_hi:[0,0,1]
    v_pk_fma_f32 v[42:43], v[42:43], s[76:77], v[22:23] neg_lo:[0,0,1] neg_hi:[0,0,1]
    v_cvt_pk_bf16_f32 v44, v36, v37
    v_cvt_pk_bf16_f32 v45, v38, v39
    v_cvt_pk_bf16_f32 v46, v40, v41
    v_cvt_pk_bf16_f32 v47, v42, v43
    global_store_dwordx4 v2, v[44:47], s[68:69] sc1
    v_add_u32 v2, 0x40000, v2
    s_waitcnt lgkmcnt(3)
    v_lshlrev_b32 v48, 16, v196
    v_and_b32 v49, 0xffff0000, v196
    v_lshlrev_b32 v50, 16, v197
    v_and_b32 v51, 0xffff0000, v197
    s_waitcnt lgkmcnt(2)
    v_lshlrev_b32 v52, 16, v198
    v_and_b32 v53, 0xffff0000, v198
    v_lshlrev_b32 v54, 16, v199
    v_and_b32 v55, 0xffff0000, v199
    v_pk_fma_f32 v[48:49], v[48:49], s[70:71], v[16:17] neg_lo:[0,0,1] neg_hi:[0,0,1]
    v_pk_fma_f32 v[50:51], v[50:51], s[72:73], v[18:19] neg_lo:[0,0,1] neg_hi:[0,0,1]
    v_pk_fma_f32 v[52:53], v[52:53], s[74:75], v[20:21] neg_lo:[0,0,1] neg_hi:[0,0,1]
    v_pk_fma_f32 v[54:55], v[54:55], s[76:77], v[22:23] neg_lo:[0,0,1] neg_hi:[0,0,1]
    v_cvt_pk_bf16_f32 v56, v48, v49
    v_cvt_pk_bf16_f32 v57, v50, v51
    v_cvt_pk_bf16_f32 v58, v52, v53
    v_cvt_pk_bf16_f32 v59, v54, v55
    global_store_dwordx4 v2, v[56:59], s[68:69] sc1
    v_add_u32 v2, 0x40000, v2
    s_waitcnt lgkmcnt(1)
    v_lshlrev_b32 v24, 16, v200
    v_and_b32 v25, 0xffff0000, v200
    v_lshlrev_b32 v26, 16, v201
    v_and_b32 v27, 0xffff0000, v201
    s_waitcnt lgkmcnt(0)
    v_lshlrev_b32 v28, 16, v202
    v_and_b32 v29, 0xffff0000, v202
    v_lshlrev_b32 v30, 16, v203
    v_and_b32 v31, 0xffff0000, v203
    v_pk_fma_f32 v[24:25], v[24:25], s[70:71], v[16:17] neg_lo:[0,0,1] neg_hi:[0,0,1]
    v_pk_fma_f32 v[26:27], v[26:27], s[72:73], v[18:19] neg_lo:[0,0,1] neg_hi:[0,0,1]
    v_pk_fma_f32 v[28:29], v[28:29], s[74:75], v[20:21] neg_lo:[0,0,1] neg_hi:[0,0,1]
    v_pk_fma_f32 v[30:31], v[30:31], s[76:77], v[22:23] neg_lo:[0,0,1] neg_hi:[0,0,1]
    v_cvt_pk_bf16_f32 v32, v24, v25
    v_cvt_pk_bf16_f32 v33, v26, v27
    v_cvt_pk_bf16_f32 v34, v28, v29
    v_cvt_pk_bf16_f32 v35, v30, v31
    global_store_dwordx4 v2, v[32:35], s[68:69] sc1
    global_load_dword v122, v123, s[66:67] sc1
    s_waitcnt vmcnt(0)
    v_cmp_gt_u32 vcc, 32, v122
    s_cbranch_vccnz LF_spininit2
LF_goinit2:
    s_and_b32 s26, s31, 31
    s_lshl_b32 s26, s26, 7
    s_add_u32 s26, s26, 131072
    v_lshl_add_u32 v122, v1, 12, s26
    v_mov_b32 v133, 1
    s_mov_b64 exec, 0xff
    global_atomic_add v122, v133, s[68:69] sc1
    s_mov_b64 exec, -1
    s_branch LF_sa_end
LF_sa_mod:
    s_cmp_lt_u32 s20, 80
    s_cbranch_scc0 LF_init
    s_cmp_eq_u32 s21, 3
    s_cbranch_scc0 LF_sa_end
    s_mul_hi_u32 s25, s20, 214748365
    s_mul_i32 s26, s25, 20
    s_sub_u32 s26, s20, s26
    s_add_u32 s26, s26, 30
    s_mul_i32 s27, s25, 320
    v_lshl_add_u32 v15, v1, 2, s27
    v_lshl_add_u32 v16, v13, 2, s27
    global_load_dword v150, v15, s[60:61]
    global_load_dword v151, v16, s[60:61] offset:256
    v_lshrrev_b32 v4, 3, v1
    v_and_b32 v5, 7, v1
    v_mul_u32_u24 v4, 7680, v4
    v_lshl_add_u32 v4, v5, 4, v4
    s_mul_i32 s27, s25, 1228800
    s_lshl_b32 s28, s26, 7
    s_add_u32 s27, s27, s28
    v_add_u32 v14, s27, v4
    s_mov_b32 m0, s33
    s_mul_i32 s25, s25, 15360
    s_lshl_b32 s26, s26, 8
    s_add_u32 s25, s25, s26
    v_lshl_add_u32 v152, v13, 2, s25
    global_load_lds_dwordx4 v14, s[62:63]
    s_add_u32 m0, m0, 1024
    v_add_u32 v14, 61440, v14
    global_load_lds_dwordx4 v14, s[62:63]
    s_add_u32 m0, m0, 1024
    v_add_u32 v14, 61440, v14
    global_load_lds_dwordx4 v14, s[62:63]
    s_add_u32 m0, m0, 1024
    v_add_u32 v14, 61440, v14
    global_load_lds_dwordx4 v14, s[62:63]
    s_add_u32 m0, m0, 1024
    v_add_u32 v14, 61440, v14
    global_load_lds_dwordx4 v14, s[62:63]
    s_add_u32 m0, m0, 1024
    v_add_u32 v14, 61440, v14
    global_load_lds_dwordx4 v14, s[62:63]
    s_add_u32 m0, m0, 1024
    v_add_u32 v14, 61440, v14
    global_load_lds_dwordx4 v14, s[62:63]
    s_add_u32 m0, m0, 1024
    v_add_u32 v14, 61440, v14
    global_load_lds_dwordx4 v14, s[62:63]
    s_add_u32 m0, m0, 1024
    v_add_u32 v14, 61440, v14
    global_load_lds_dwordx4 v14, s[62:63]
    s_add_u32 m0, m0, 1024
    v_add_u32 v14, 61440, v14
    global_load_lds_dwordx4 v14, s[62:63]
    s_add_u32 m0, m0, 1024
    v_add_u32 v14, 61440, v14
    global_load_lds_dwordx4 v14, s[62:63]
    s_add_u32 m0, m0, 1024
    v_add_u32 v14, 61440, v14
    global_load_lds_dwordx4 v14, s[62:63]
    s_add_u32 m0, m0, 1024
    v_add_u32 v14, 61440, v14
    global_load_lds_dwordx4 v14, s[62:63]
    s_add_u32 m0, m0, 1024
    v_add_u32 v14, 61440, v14
    global_load_lds_dwordx4 v14, s[62:63]
    s_add_u32 m0, m0, 1024
    v_add_u32 v14, 61440, v14
    global_load_lds_dwordx4 v14, s[62:63]
    s_add_u32 m0, m0, 1024
    v_add_u32 v14, 61440, v14
    global_load_lds_dwordx4 v14, s[62:63]
    s_add_u32 m0, m0, 1024
    v_add_u32 v14, 61440, v14
    global_load_lds_dwordx4 v14, s[62:63]
    s_add_u32 m0, m0, 1024
    v_add_u32 v14, 61440, v14
    global_load_lds_dwordx4 v14, s[62:63]
    s_add_u32 m0, m0, 1024
    v_add_u32 v14, 61440, v14
    global_load_lds_dwordx4 v14, s[62:63]
    s_add_u32 m0, m0, 1024
    v_add_u32 v14, 61440, v14
    global_load_lds_dwordx4 v14, s[62:63]
    v_lshl_add_u32 v5, v12, 3, v11
    v_lshlrev_b32 v5, 7, v5
    v_lshl_add_u32 v5, v10, 3, v5
    v_add_u32 v5, s33, v5
    s_add_u32 s27, s33, 20480
    v_lshl_add_u32 v158, v1, 2, s27
    v_lshl_add_u32 v159, v13, 2, s27
    v_lshl_add_u32 v160, v12, 4, s27
    s_waitcnt vmcnt(20)
    s_mov_b32 s24, 3216550459
    v_lshlrev_b32 v16, 16, v150
    v_and_b32 v17, 0xffff0000, v150
    v_lshlrev_b32 v18, 16, v151
    v_and_b32 v19, 0xffff0000, v151
    v_mul_f32 v20, s24, v16
    v_mul_f32 v21, s24, v17
    v_mul_f32 v22, s24, v18
    v_mul_f32 v23, s24, v19
    v_exp_f32 v20, v20
    v_exp_f32 v21, v21
    v_exp_f32 v22, v22
    v_exp_f32 v23, v23
    v_add_f32 v20, 1.0, v20
    v_add_f32 v21, 1.0, v21
    v_add_f32 v22, 1.0, v22
    v_add_f32 v23, 1.0, v23
    v_rcp_f32 v20, v20
    v_rcp_f32 v21, v21
    v_rcp_f32 v22, v22
    v_rcp_f32 v23, v23
    v_mul_f32 v16, v16, v20
    v_mul_f32 v17, v17, v21
    v_mul_f32 v18, v18, v22
    v_mul_f32 v19, v19, v23
    v_cvt_pk_bf16_f32 v16, v16, v17
    v_cvt_pk_bf16_f32 v17, v18, v19
    ds_write_b32 v158, v16
    ds_write_b32 v159, v17 offset:256
    ds_read_b128 v[24:27], v160 offset:0
    ds_read_b128 v[28:31], v160 offset:64
    ds_read_b128 v[32:35], v160 offset:128
    ds_read_b128 v[36:39], v160 offset:192
    ds_read_b128 v[40:43], v160 offset:256
    s_waitcnt vmcnt(16)
    ds_read_b64_tr_b16 v[60:61], v5 offset:0
    ds_read_b64_tr_b16 v[62:63], v5 offset:512
    ds_read_b64_tr_b16 v[64:65], v5 offset:32
    ds_read_b64_tr_b16 v[66:67], v5 offset:544
    ds_read_b64_tr_b16 v[68:69], v5 offset:64
    ds_read_b64_tr_b16 v[70:71], v5 offset:576
    ds_read_b64_tr_b16 v[72:73], v5 offset:96
    ds_read_b64_tr_b16 v[74:75], v5 offset:608
    s_waitcnt lgkmcnt(6)
    v_mfma_f32_16x16x32_bf16 v[44:47], v[24:27], v[60:63], 0
    s_waitcnt lgkmcnt(4)
    v_mfma_f32_16x16x32_bf16 v[48:51], v[24:27], v[64:67], 0
    s_waitcnt lgkmcnt(2)
    v_mfma_f32_16x16x32_bf16 v[52:55], v[24:27], v[68:71], 0
    s_waitcnt lgkmcnt(0)
    v_mfma_f32_16x16x32_bf16 v[56:59], v[24:27], v[72:75], 0
    s_waitcnt vmcnt(12)
    ds_read_b64_tr_b16 v[76:77], v5 offset:4096
    ds_read_b64_tr_b16 v[78:79], v5 offset:4608
    ds_read_b64_tr_b16 v[80:81], v5 offset:4128
    ds_read_b64_tr_b16 v[82:83], v5 offset:4640
    ds_read_b64_tr_b16 v[84:85], v5 offset:4160
    ds_read_b64_tr_b16 v[86:87], v5 offset:4672
    ds_read_b64_tr_b16 v[88:89], v5 offset:4192
    ds_read_b64_tr_b16 v[90:91], v5 offset:4704
    s_waitcnt lgkmcnt(6)
    v_mfma_f32_16x16x32_bf16 v[44:47], v[28:31], v[76:79], v[44:47]
    s_waitcnt lgkmcnt(4)
    v_mfma_f32_16x16x32_bf16 v[48:51], v[28:31], v[80:83], v[48:51]
    s_waitcnt lgkmcnt(2)
    v_mfma_f32_16x16x32_bf16 v[52:55], v[28:31], v[84:87], v[52:55]
    s_waitcnt lgkmcnt(0)
    v_mfma_f32_16x16x32_bf16 v[56:59], v[28:31], v[88:91], v[56:59]
    s_waitcnt vmcnt(8)
    ds_read_b64_tr_b16 v[60:61], v5 offset:8192
    ds_read_b64_tr_b16 v[62:63], v5 offset:8704
    ds_read_b64_tr_b16 v[64:65], v5 offset:8224
    ds_read_b64_tr_b16 v[66:67], v5 offset:8736
    ds_read_b64_tr_b16 v[68:69], v5 offset:8256
    ds_read_b64_tr_b16 v[70:71], v5 offset:8768
    ds_read_b64_tr_b16 v[72:73], v5 offset:8288
    ds_read_b64_tr_b16 v[74:75], v5 offset:8800
    s_waitcnt lgkmcnt(6)
    v_mfma_f32_16x16x32_bf16 v[44:47], v[32:35], v[60:63], v[44:47]
    s_waitcnt lgkmcnt(4)
    v_mfma_f32_16x16x32_bf16 v[48:51], v[32:35], v[64:67], v[48:51]
    s_waitcnt lgkmcnt(2)
    v_mfma_f32_16x16x32_bf16 v[52:55], v[32:35], v[68:71], v[52:55]
    s_waitcnt lgkmcnt(0)
    v_mfma_f32_16x16x32_bf16 v[56:59], v[32:35], v[72:75], v[56:59]
    s_waitcnt vmcnt(4)
    ds_read_b64_tr_b16 v[76:77], v5 offset:12288
    ds_read_b64_tr_b16 v[78:79], v5 offset:12800
    ds_read_b64_tr_b16 v[80:81], v5 offset:12320
    ds_read_b64_tr_b16 v[82:83], v5 offset:12832
    ds_read_b64_tr_b16 v[84:85], v5 offset:12352
    ds_read_b64_tr_b16 v[86:87], v5 offset:12864
    ds_read_b64_tr_b16 v[88:89], v5 offset:12384
    ds_read_b64_tr_b16 v[90:91], v5 offset:12896
    s_waitcnt lgkmcnt(6)
    v_mfma_f32_16x16x32_bf16 v[44:47], v[36:39], v[76:79], v[44:47]
    s_waitcnt lgkmcnt(4)
    v_mfma_f32_16x16x32_bf16 v[48:51], v[36:39], v[80:83], v[48:51]
    s_waitcnt lgkmcnt(2)
    v_mfma_f32_16x16x32_bf16 v[52:55], v[36:39], v[84:87], v[52:55]
    s_waitcnt lgkmcnt(0)
    v_mfma_f32_16x16x32_bf16 v[56:59], v[36:39], v[88:91], v[56:59]
    s_waitcnt vmcnt(0)
    ds_read_b64_tr_b16 v[60:61], v5 offset:16384
    ds_read_b64_tr_b16 v[62:63], v5 offset:16896
    ds_read_b64_tr_b16 v[64:65], v5 offset:16416
    ds_read_b64_tr_b16 v[66:67], v5 offset:16928
    ds_read_b64_tr_b16 v[68:69], v5 offset:16448
    ds_read_b64_tr_b16 v[70:71], v5 offset:16960
    ds_read_b64_tr_b16 v[72:73], v5 offset:16480
    ds_read_b64_tr_b16 v[74:75], v5 offset:16992
    s_waitcnt lgkmcnt(6)
    v_mfma_f32_16x16x32_bf16 v[44:47], v[40:43], v[60:63], v[44:47]
    s_waitcnt lgkmcnt(4)
    v_mfma_f32_16x16x32_bf16 v[48:51], v[40:43], v[64:67], v[48:51]
    s_waitcnt lgkmcnt(2)
    v_mfma_f32_16x16x32_bf16 v[52:55], v[40:43], v[68:71], v[52:55]
    s_waitcnt lgkmcnt(0)
    v_mfma_f32_16x16x32_bf16 v[56:59], v[40:43], v[72:75], v[56:59]
    s_mov_b64 exec, 0xffff
    s_nop 0
    global_store_dword v152, v44, s[68:69] offset:0 sc1
    s_nop 0
    global_store_dword v152, v48, s[68:69] offset:64 sc1
    s_nop 0
    global_store_dword v152, v52, s[68:69] offset:128 sc1
    s_nop 0
    global_store_dword v152, v56, s[68:69] offset:192 sc1
    s_mov_b64 exec, -1
    v_mov_b32 v123, 0
    global_load_dword v122, v123, s[66:67] sc1
    s_waitcnt vmcnt(0)
    v_cmp_gt_u32 vcc, 32, v122
    s_cbranch_vccnz LF_spininit3
LF_goinit3:
    s_and_b32 s26, s2, 15
    s_lshl_b32 s26, s26, 7
    s_add_u32 s26, s26, 163844
    v_lshl_add_u32 v122, v1, 12, s26
    v_mov_b32 v133, 1
    s_mov_b64 exec, 0xff
    global_atomic_add v122, v133, s[68:69] sc1
    s_mov_b64 exec, -1
LF_sa_w1:
    s_lshr_b32 s34, s20, 2
    s_and_b32 s35, s20, 3
    v_lshrrev_b32 v2, 3, v1
    v_and_b32 v3, 6, v2
    v_and_b32 v4, 7, v1
    v_xor_b32 v3, v3, v4
    v_mul_u32_u24 v2, 3072, v2
    v_lshl_add_u32 v2, v3, 4, v2
    s_mul_i32 s35, s35, 491520
    s_lshl_b32 s34, s34, 7
    s_add_u32 s35, s35, s34
    s_mov_b32 m0, 102400
    v_add_u32 v2, s35, v2
    global_load_lds_dwordx4 v2, s[56:57]
    s_add_u32 m0, m0, 1024
    v_add_u32 v2, 24576, v2
    global_load_lds_dwordx4 v2, s[56:57]
    s_add_u32 m0, m0, 1024
    v_add_u32 v2, 24576, v2
    global_load_lds_dwordx4 v2, s[56:57]
    s_add_u32 m0, m0, 1024
    v_add_u32 v2, 24576, v2
    global_load_lds_dwordx4 v2, s[56:57]
    s_add_u32 m0, m0, 1024
    v_add_u32 v2, 24576, v2
    global_load_lds_dwordx4 v2, s[56:57]
    s_add_u32 m0, m0, 1024
    v_add_u32 v2, 24576, v2
    global_load_lds_dwordx4 v2, s[56:57]
    s_add_u32 m0, m0, 1024
    v_add_u32 v2, 24576, v2
    global_load_lds_dwordx4 v2, s[56:57]
    s_add_u32 m0, m0, 1024
    v_add_u32 v2, 24576, v2
    global_load_lds_dwordx4 v2, s[56:57]
    s_add_u32 m0, m0, 1024
    v_add_u32 v2, 24576, v2
    global_load_lds_dwordx4 v2, s[56:57]
    s_add_u32 m0, m0, 1024
    v_add_u32 v2, 24576, v2
    global_load_lds_dwordx4 v2, s[56:57]
    s_add_u32 m0, m0, 1024
    v_add_u32 v2, 24576, v2
    global_load_lds_dwordx4 v2, s[56:57]
    s_add_u32 m0, m0, 1024
    v_add_u32 v2, 24576, v2
    global_load_lds_dwordx4 v2, s[56:57]
    s_add_u32 m0, m0, 1024
    v_add_u32 v2, 24576, v2
    global_load_lds_dwordx4 v2, s[56:57]
    s_add_u32 m0, m0, 1024
    v_add_u32 v2, 24576, v2
    global_load_lds_dwordx4 v2, s[56:57]
    s_add_u32 m0, m0, 1024
    v_add_u32 v2, 24576, v2
    global_load_lds_dwordx4 v2, s[56:57]
    s_add_u32 m0, m0, 1024
    v_add_u32 v2, 24576, v2
    global_load_lds_dwordx4 v2, s[56:57]
    s_add_u32 m0, m0, 1024
    v_add_u32 v2, 24576, v2
    global_load_lds_dwordx4 v2, s[56:57]
    s_add_u32 m0, m0, 1024
    v_add_u32 v2, 24576, v2
    global_load_lds_dwordx4 v2, s[56:57]
    s_add_u32 m0, m0, 1024
    v_add_u32 v2, 24576, v2
    global_load_lds_dwordx4 v2, s[56:57]
    s_add_u32 m0, m0, 1024
    v_add_u32 v2, 24576, v2
    global_load_lds_dwordx4 v2, s[56:57]
LF_sa_end:
    s_lshr_b32 s34, s20, 2
    s_and_b32 s35, s20, 3
    s_lshl_b32 s32, s34, 2
    s_add_u32 s32, s32, s21
    s_mul_i32 s26, s21, 5120
    s_add_u32 m0, s26, 122880
    s_lshr_b32 s24, s20, 1
    s_and_b32 s25, s20, 1
    s_mul_i32 s33, s24, 40960
    s_mul_i32 s26, s25, 640
    s_add_u32 s33, s33, s26
    s_mul_i32 s27, s21, 320
    v_add_u32 v3, 0, v1
    v_add_u32 v3, s27, v3
    v_mul_u32_u24 v4, 1639, v3
    v_lshrrev_b32 v4, 16, v4
    v_mul_u32_u24 v4, 640, v4
    v_lshl_add_u32 v3, v3, 4, v4
    v_add_u32 v3, s33, v3
    global_load_lds_dwordx4 v3, s[58:59]
    s_add_u32 m0, m0, 1024
    v_add_u32 v3, 64, v1
    v_add_u32 v3, s27, v3
    v_mul_u32_u24 v4, 1639, v3
    v_lshrrev_b32 v4, 16, v4
    v_mul_u32_u24 v4, 640, v4
    v_lshl_add_u32 v3, v3, 4, v4
    v_add_u32 v3, s33, v3
    global_load_lds_dwordx4 v3, s[58:59]
    s_add_u32 m0, m0, 1024
    v_add_u32 v3, 128, v1
    v_add_u32 v3, s27, v3
    v_mul_u32_u24 v4, 1639, v3
    v_lshrrev_b32 v4, 16, v4
    v_mul_u32_u24 v4, 640, v4
    v_lshl_add_u32 v3, v3, 4, v4
    v_add_u32 v3, s33, v3
    global_load_lds_dwordx4 v3, s[58:59]
    s_add_u32 m0, m0, 1024
    v_add_u32 v3, 192, v1
    v_add_u32 v3, s27, v3
    v_mul_u32_u24 v4, 1639, v3
    v_lshrrev_b32 v4, 16, v4
    v_mul_u32_u24 v4, 640, v4
    v_lshl_add_u32 v3, v3, 4, v4
    v_add_u32 v3, s33, v3
    global_load_lds_dwordx4 v3, s[58:59]
    s_add_u32 m0, m0, 1024
    v_add_u32 v3, 256, v1
    v_add_u32 v3, s27, v3
    v_mul_u32_u24 v4, 1639, v3
    v_lshrrev_b32 v4, 16, v4
    v_mul_u32_u24 v4, 640, v4
    v_lshl_add_u32 v3, v3, 4, v4
    v_add_u32 v3, s33, v3
    global_load_lds_dwordx4 v3, s[58:59]
    v_bfe_u32 v11, v1, 2, 2
    v_lshrrev_b32 v12, 4, v1
    v_and_b32 v10, 3, v1
    v_and_b32 v13, 15, v1
    v_lshl_add_u32 v9, v12, 2, v11
    v_mul_u32_u24 v9, 640, v9
    v_lshl_add_u32 v9, v10, 3, v9
    s_mul_i32 s26, s21, 160
    s_add_u32 s26, s26, 122880
    v_add_u32 v9, s26, v9
    v_lshrrev_b32 v5, 1, v12
    v_and_b32 v6, 1, v12
    v_lshlrev_b32 v5, 4, v5
    v_lshl_add_u32 v5, v6, 2, v5
    v_add_u32 v2, v5, v11
    v_and_b32 v3, 6, v2
    s_lshl_b32 s26, s21, 1
    v_xor_b32 v3, s26, v3
    v_lshrrev_b32 v4, 1, v10
    v_add_u32 v3, v3, v4
    v_lshlrev_b32 v3, 4, v3
    v_lshl_add_u32 v3, v2, 7, v3
    v_and_b32 v4, 1, v1
    v_lshl_add_u32 v3, v4, 3, v3
    v_add_u32 v130, 102400, v3
    s_mul_hi_u32 s26, s24, 0x15555556
    s_mul_i32 s27, s26, 12
    s_sub_u32 s27, s24, s27
    s_lshl_b32 s27, s27, 2
    s_mov_b32 s28, 2755207552
    s_mov_b32 s29, 31589
    s_lshr_b64 s[28:29], s[28:29], s27
    s_and_b32 s27, s28, 15
    s_lshl_b32 s28, s25, 2
    s_add_u32 s28, s28, s21
    s_lshl_b32 s28, s28, 2
    s_add_u32 s26, s26, s28
    s_mul_i32 s26, s26, 12
    s_add_u32 s26, s26, s27
    s_mul_i32 s26, s26, 5120
    s_add_u32 s26, s26, 15728640
    v_add_u32 v129, s26, v8
    s_mul_i32 s26, s35, 640
    s_add_u32 s26, s26, 7680
    v_lshl_add_u32 v14, v1, 2, s26
    v_and_b32 v15, 31, v1
    v_lshl_add_u32 v15, v15, 2, s26
    s_mul_hi_u32 s26, s32, 0x55555556
    s_mul_i32 s27, s26, 3
    s_sub_u32 s27, s32, s27
    s_add_u32 s28, s27, 2
    s_cmp_ge_u32 s28, 3
    s_cselect_b32 s29, 3, 0
    s_sub_u32 s28, s28, s29
    s_bitcmp1_b32 s26, 0
    s_cselect_b32 s27, s28, s27
    s_mul_i32 s26, s26, 60
    s_mul_i32 s28, s35, 10
    s_add_u32 s28, s28, s27
    s_mul_i32 s29, s35, 5
    s_add_u32 s29, s29, 40
    s_cmp_lt_u32 s27, 2
    s_cselect_b32 s28, s28, s29
    s_cselect_b32 s33, 2, 1
    s_lshl_b32 s33, s33, 10
    s_add_u32 s26, s26, s28
    s_lshl_b32 s26, s26, 10
    s_add_u32 s26, s26, 13631488
    v_add_u32 v128, s26, v8
    s_lshl_b32 s26, s21, 10
    s_add_u32 s26, s26, 143360
    v_lshl_add_u32 v6, v1, 2, s26
    v_and_b32 v7, 31, v1
    v_lshl_add_u32 v2, v7, 1, s26
    v_lshl_add_u32 v7, v7, 2, s26
    v_lshl_add_u32 v4, v1, 1, s26
    v_lshl_add_u32 v3, v5, 1, s26
    v_lshl_add_u32 v5, v5, 2, s26
    s_mul_i32 s26, s35, 12288
    s_lshl_b32 s27, s32, 6
    s_add_u32 s26, s26, s27
    s_add_u32 s26, s26, 65536
    v_lshl_add_u32 v127, v12, 4, s26
    v_add_u32 v126, 6144, v127
    s_lshl_b32 s26, s32, 7
    s_lshl_b32 s27, s35, 2
    s_add_u32 s26, s26, s27
    s_add_u32 s26, s26, 229376
    v_mov_b32 v125, s26
    v_mov_b32 v124, 1
    v_mov_b32 v100, 0x3f803f80
    v_mov_b32 v101, 0x3f803f80
    v_mov_b32 v102, 0x3f803f80
    v_mov_b32 v103, 0x3f803f80
    s_and_b32 s26, s2, 7
    s_lshl_b32 s26, s26, 12
    s_add_u32 s26, s26, 163844
    v_and_b32 v123, 15, v1
    v_lshl_add_u32 v123, v123, 7, s26
    s_waitcnt vmcnt(0)
    s_barrier
    v_mov_b32 v133, 5
    ds_read_b64_tr_b16 v[16:17], v9 offset:0
    ds_read_b64_tr_b16 v[18:19], v9 offset:10240
    ds_read_b64_tr_b16 v[20:21], v9 offset:32
    ds_read_b64_tr_b16 v[22:23], v9 offset:10272
    ds_read_b64_tr_b16 v[24:25], v9 offset:64
    ds_read_b64_tr_b16 v[26:27], v9 offset:10304
    ds_read_b64_tr_b16 v[28:29], v9 offset:96
    ds_read_b64_tr_b16 v[30:31], v9 offset:10336
    ds_read_b64_tr_b16 v[32:33], v9 offset:128
    ds_read_b64_tr_b16 v[34:35], v9 offset:10368
    ds_read_b64_tr_b16 v[40:41], v130 offset:0
    ds_read_b64_tr_b16 v[42:43], v130 offset:1024
    ds_read_b64_tr_b16 v[44:45], v130 offset:4096
    ds_read_b64_tr_b16 v[46:47], v130 offset:5120
    ds_read_b64_tr_b16 v[48:49], v130 offset:8192
    ds_read_b64_tr_b16 v[50:51], v130 offset:9216
    ds_read_b64_tr_b16 v[52:53], v130 offset:12288
    ds_read_b64_tr_b16 v[54:55], v130 offset:13312
    ds_read_b64_tr_b16 v[56:57], v130 offset:16384
    ds_read_b64_tr_b16 v[58:59], v130 offset:17408
    s_waitcnt lgkmcnt(9)
    v_lshlrev_b32 v136, 16, v40
    v_and_b32 v137, 0xffff0000, v40
    v_lshlrev_b32 v138, 16, v41
    v_and_b32 v139, 0xffff0000, v41
    s_waitcnt lgkmcnt(8)
    v_lshlrev_b32 v140, 16, v42
    v_and_b32 v141, 0xffff0000, v42
    v_lshlrev_b32 v142, 16, v43
    v_and_b32 v143, 0xffff0000, v43
    s_waitcnt lgkmcnt(7)
    v_lshlrev_b32 v144, 16, v44
    v_and_b32 v145, 0xffff0000, v44
    v_lshlrev_b32 v146, 16, v45
    v_and_b32 v147, 0xffff0000, v45
    s_waitcnt lgkmcnt(6)
    v_lshlrev_b32 v148, 16, v46
    v_and_b32 v149, 0xffff0000, v46
    v_lshlrev_b32 v150, 16, v47
    v_and_b32 v151, 0xffff0000, v47
    s_waitcnt lgkmcnt(5)
    v_lshlrev_b32 v152, 16, v48
    v_and_b32 v153, 0xffff0000, v48
    v_lshlrev_b32 v154, 16, v49
    v_and_b32 v155, 0xffff0000, v49
    s_waitcnt lgkmcnt(4)
    v_lshlrev_b32 v156, 16, v50
    v_and_b32 v157, 0xffff0000, v50
    v_lshlrev_b32 v158, 16, v51
    v_and_b32 v159, 0xffff0000, v51
    s_waitcnt lgkmcnt(3)
    v_lshlrev_b32 v160, 16, v52
    v_and_b32 v161, 0xffff0000, v52
    v_lshlrev_b32 v162, 16, v53
    v_and_b32 v163, 0xffff0000, v53
    s_waitcnt lgkmcnt(2)
    v_lshlrev_b32 v164, 16, v54
    v_and_b32 v165, 0xffff0000, v54
    v_lshlrev_b32 v166, 16, v55
    v_and_b32 v167, 0xffff0000, v55
    s_waitcnt lgkmcnt(1)
    v_lshlrev_b32 v168, 16, v56
    v_and_b32 v169, 0xffff0000, v56
    v_lshlrev_b32 v170, 16, v57
    v_and_b32 v171, 0xffff0000, v57
    s_waitcnt lgkmcnt(0)
    v_lshlrev_b32 v172, 16, v58
    v_and_b32 v173, 0xffff0000, v58
    v_lshlrev_b32 v174, 16, v59
    v_and_b32 v175, 0xffff0000, v59
    s_cmp_eq_u32 s21, 0
    s_cbranch_scc0 LF_sd2
    global_load_dword v122, v123, s[68:69] sc1
    s_waitcnt vmcnt(0)
    v_cmp_gt_u32 vcc, v133, v122
    s_cbranch_vccnz LF_spinsm
LF_gosm:
LF_sd2:
    s_barrier
    global_load_dword v60, v14, s[68:69] offset:0 sc1
    global_load_dword v61, v14, s[68:69] offset:256 sc1
    global_load_dword v62, v15, s[68:69] offset:512 sc1
    global_load_dword v63, v14, s[68:69] offset:2560 sc1
    global_load_dword v64, v14, s[68:69] offset:2816 sc1
    global_load_dword v65, v15, s[68:69] offset:3072 sc1
    v_add_u32 v14, 15360, v14
    v_add_u32 v15, 15360, v15
    global_load_dword v66, v14, s[68:69] offset:0 sc1
    global_load_dword v67, v14, s[68:69] offset:256 sc1
    global_load_dword v68, v15, s[68:69] offset:512 sc1
    global_load_dword v69, v14, s[68:69] offset:2560 sc1
    global_load_dword v70, v14, s[68:69] offset:2816 sc1
    global_load_dword v71, v15, s[68:69] offset:3072 sc1
    v_add_u32 v14, 15360, v14
    v_add_u32 v15, 15360, v15
    global_load_dword v72, v14, s[68:69] offset:0 sc1
    global_load_dword v73, v14, s[68:69] offset:256 sc1
    global_load_dword v74, v15, s[68:69] offset:512 sc1
    global_load_dword v75, v14, s[68:69] offset:2560 sc1
    global_load_dword v76, v14, s[68:69] offset:2816 sc1
    global_load_dword v77, v15, s[68:69] offset:3072 sc1
    v_add_u32 v14, 15360, v14
    v_add_u32 v15, 15360, v15
    global_load_dword v78, v14, s[68:69] offset:0 sc1
    global_load_dword v79, v14, s[68:69] offset:256 sc1
    global_load_dword v80, v15, s[68:69] offset:512 sc1
    global_load_dword v81, v14, s[68:69] offset:2560 sc1
    global_load_dword v82, v14, s[68:69] offset:2816 sc1
    global_load_dword v83, v15, s[68:69] offset:3072 sc1
    global_store_dwordx4 v129, v[16:19], s[68:69] sc1
    v_add_u32 v129, 1024, v129
    global_store_dwordx4 v129, v[20:23], s[68:69] sc1
    v_add_u32 v129, 1024, v129
    global_store_dwordx4 v129, v[24:27], s[68:69] sc1
    v_add_u32 v129, 1024, v129
    global_store_dwordx4 v129, v[28:31], s[68:69] sc1
    v_add_u32 v129, 1024, v129
    global_store_dwordx4 v129, v[32:35], s[68:69] sc1
    s_waitcnt vmcnt(21)
    v_pk_add_f32 v[60:61], v[60:61], v[66:67]
    s_waitcnt vmcnt(19)
    v_pk_add_f32 v[62:63], v[62:63], v[68:69]
    s_waitcnt vmcnt(17)
    v_pk_add_f32 v[64:65], v[64:65], v[70:71]
    s_waitcnt vmcnt(9)
    v_pk_add_f32 v[72:73], v[72:73], v[78:79]
    s_waitcnt vmcnt(7)
    v_pk_add_f32 v[74:75], v[74:75], v[80:81]
    s_waitcnt vmcnt(5)
    v_pk_add_f32 v[76:77], v[76:77], v[82:83]
    v_pk_add_f32 v[60:61], v[60:61], v[72:73]
    v_pk_add_f32 v[62:63], v[62:63], v[74:75]
    v_pk_add_f32 v[64:65], v[64:65], v[76:77]
    v_cvt_pk_bf16_f32 v60, v63, v60
    v_cvt_pk_bf16_f32 v61, v64, v61
    v_cvt_pk_bf16_f32 v62, v65, v62
    v_lshlrev_b32 v63, 16, v60
    ds_write_b16_d16_hi v4, v60 offset:640
    v_lshlrev_b32 v64, 16, v61
    ds_write_b16_d16_hi v4, v61 offset:768
    v_lshlrev_b32 v65, 16, v62
    ds_write_b16_d16_hi v2, v62 offset:896
    v_add_f32 v63, 1.0, v63
    v_add_f32 v64, 1.0, v64
    v_add_f32 v65, 1.0, v65
    v_cvt_pk_bf16_f32 v63, v63, v63
    v_cvt_pk_bf16_f32 v64, v64, v64
    v_cvt_pk_bf16_f32 v65, v65, v65
    v_lshlrev_b32 v63, 16, v63
    ds_write_b32 v6, v63 offset:0
    v_lshlrev_b32 v64, 16, v64
    ds_write_b32 v6, v64 offset:256
    v_lshlrev_b32 v65, 16, v65
    ds_write_b32 v7, v65 offset:512
    ds_read_b128 v[180:183], v5 offset:0
    ds_read_b128 v[184:187], v5 offset:32
    ds_read_b64 v[188:189], v3 offset:640
    ds_read_b64 v[190:191], v3 offset:656
    ds_read_b128 v[192:195], v5 offset:128
    ds_read_b128 v[196:199], v5 offset:160
    ds_read_b64 v[200:201], v3 offset:704
    ds_read_b64 v[202:203], v3 offset:720
    ds_read_b128 v[204:207], v5 offset:256
    ds_read_b128 v[208:211], v5 offset:288
    ds_read_b64 v[212:213], v3 offset:768
    ds_read_b64 v[214:215], v3 offset:784
    ds_read_b128 v[216:219], v5 offset:384
    ds_read_b128 v[220:223], v5 offset:416
    ds_read_b64 v[224:225], v3 offset:832
    ds_read_b64 v[226:227], v3 offset:848
    ds_read_b128 v[228:231], v5 offset:512
    ds_read_b128 v[232:235], v5 offset:544
    ds_read_b64 v[236:237], v3 offset:896
    ds_read_b64 v[238:239], v3 offset:912
    s_waitcnt lgkmcnt(15)
    v_pk_mul_f32 v[136:137], v[136:137], v[180:181]
    v_pk_mul_f32 v[138:139], v[138:139], v[182:183]
    v_pk_mul_f32 v[140:141], v[140:141], v[184:185]
    v_pk_mul_f32 v[142:143], v[142:143], v[186:187]
    v_cvt_pk_bf16_f32 v64, v136, v137
    v_cvt_pk_bf16_f32 v65, v138, v139
    v_cvt_pk_bf16_f32 v66, v140, v141
    v_cvt_pk_bf16_f32 v67, v142, v143
    global_store_dwordx4 v128, v[64:67], s[68:69] sc1
    v_add_u32 v128, s33, v128
    v_pk_mul_f32 v[144:145], v[144:145], v[192:193]
    v_pk_mul_f32 v[146:147], v[146:147], v[194:195]
    s_waitcnt lgkmcnt(14)
    v_pk_mul_f32 v[148:149], v[148:149], v[196:197]
    v_pk_mul_f32 v[150:151], v[150:151], v[198:199]
    v_cvt_pk_bf16_f32 v68, v144, v145
    v_cvt_pk_bf16_f32 v69, v146, v147
    v_cvt_pk_bf16_f32 v70, v148, v149
    v_cvt_pk_bf16_f32 v71, v150, v151
    global_store_dwordx4 v128, v[68:71], s[68:69] sc1
    v_add_u32 v128, s33, v128
    s_waitcnt lgkmcnt(11)
    v_pk_mul_f32 v[152:153], v[152:153], v[204:205]
    v_pk_mul_f32 v[154:155], v[154:155], v[206:207]
    s_waitcnt lgkmcnt(10)
    v_pk_mul_f32 v[156:157], v[156:157], v[208:209]
    v_pk_mul_f32 v[158:159], v[158:159], v[210:211]
    v_cvt_pk_bf16_f32 v72, v152, v153
    v_cvt_pk_bf16_f32 v73, v154, v155
    v_cvt_pk_bf16_f32 v74, v156, v157
    v_cvt_pk_bf16_f32 v75, v158, v159
    global_store_dwordx4 v128, v[72:75], s[68:69] sc1
    v_add_u32 v128, s33, v128
    s_waitcnt lgkmcnt(7)
    v_pk_mul_f32 v[160:161], v[160:161], v[216:217]
    v_pk_mul_f32 v[162:163], v[162:163], v[218:219]
    s_waitcnt lgkmcnt(6)
    v_pk_mul_f32 v[164:165], v[164:165], v[220:221]
    v_pk_mul_f32 v[166:167], v[166:167], v[222:223]
    v_cvt_pk_bf16_f32 v76, v160, v161
    v_cvt_pk_bf16_f32 v77, v162, v163
    v_cvt_pk_bf16_f32 v78, v164, v165
    v_cvt_pk_bf16_f32 v79, v166, v167
    global_store_dwordx4 v128, v[76:79], s[68:69] sc1
    v_add_u32 v128, s33, v128
    s_waitcnt lgkmcnt(3)
    v_pk_mul_f32 v[168:169], v[168:169], v[228:229]
    v_pk_mul_f32 v[170:171], v[170:171], v[230:231]
    s_waitcnt lgkmcnt(2)
    v_pk_mul_f32 v[172:173], v[172:173], v[232:233]
    v_pk_mul_f32 v[174:175], v[174:175], v[234:235]
    v_cvt_pk_bf16_f32 v80, v168, v169
    v_cvt_pk_bf16_f32 v81, v170, v171
    v_cvt_pk_bf16_f32 v82, v172, v173
    v_cvt_pk_bf16_f32 v83, v174, v175
    global_store_dwordx4 v128, v[80:83], s[68:69] sc1
    v_mfma_f32_16x16x32_bf16 v[112:115], v[64:67], v[100:103], 0
    v_mfma_f32_16x16x32_bf16 v[116:119], v[40:43], v[188:191], 0
    v_mfma_f32_16x16x32_bf16 v[112:115], v[68:71], v[100:103], v[112:115]
    v_mfma_f32_16x16x32_bf16 v[116:119], v[44:47], v[200:203], v[116:119]
    v_mfma_f32_16x16x32_bf16 v[112:115], v[72:75], v[100:103], v[112:115]
    v_mfma_f32_16x16x32_bf16 v[116:119], v[48:51], v[212:215], v[116:119]
    v_mfma_f32_16x16x32_bf16 v[112:115], v[76:79], v[100:103], v[112:115]
    v_mfma_f32_16x16x32_bf16 v[116:119], v[52:55], v[224:227], v[116:119]
    v_mfma_f32_16x16x32_bf16 v[112:115], v[80:83], v[100:103], v[112:115]
    s_waitcnt lgkmcnt(0)
    v_mfma_f32_16x16x32_bf16 v[116:119], v[56:59], v[236:239], v[116:119]
    s_mov_b32 exec_lo, 0x00010001
    s_mov_b32 exec_hi, 0x00010001
    s_nop 3
    global_store_dwordx4 v127, v[112:115], s[68:69] sc1
    s_nop 0
    global_store_dwordx4 v126, v[116:119], s[68:69] sc1
    s_mov_b64 exec, -1
    s_waitcnt vmcnt(0)
    s_mov_b64 exec, 1
    global_store_dword v125, v124, s[68:69] sc1
    s_mov_b64 exec, -1
    v_bfe_u32 v11, v1, 2, 2
    v_lshrrev_b32 v12, 4, v1
    v_and_b32 v10, 3, v1
    v_and_b32 v13, 15, v1
    s_and_b32 s24, s2, 7
    s_lshr_b32 s25, s2, 3
    s_lshr_b32 s22, s24, 1
    s_lshl_b32 s22, s22, 3
    s_lshr_b32 s26, s25, 2
    s_add_u32 s22, s22, s26
    s_and_b32 s23, s24, 1
    s_lshl_b32 s23, s23, 2
    s_and_b32 s26, s25, 3
    s_add_u32 s23, s23, s26
    s_mul_i32 s26, s23, 12
    s_mul_i32 s25, s21, 3
    s_add_u32 s25, s26, s25
    s_lshl_b32 s26, s25, 7
    s_add_u32 s26, s26, 229376
    v_min_u32 v250, 11, v1
    v_lshrrev_b32 v251, 2, v250
    v_lshl_add_u32 v251, v251, 7, s26
    v_and_b32 v250, 3, v250
    v_lshl_add_u32 v251, v250, 2, v251
    s_lshl_b32 s24, s23, 2
    s_add_u32 s24, s24, s21
    s_mul_i32 s24, s24, 61440
    s_add_u32 s26, s24, 13631488
    s_add_u32 s4, s68, s26
    s_addc_u32 s5, s69, 0
    s_mov_b32 s6, 61440
    s_mov_b32 s7, 0x20000
    s_add_u32 s26, s24, 15728640
    s_add_u32 s8, s68, s26
    s_addc_u32 s9, s69, 0
    s_mov_b32 s10, 61440
    s_mov_b32 s11, 0x20000
    s_mul_i32 s26, s22, 196608
    s_add_u32 s26, s26, 17825792
    s_add_u32 s12, s68, s26
    s_addc_u32 s13, s69, 0
    s_mov_b32 s14, 196608
    s_mov_b32 s15, 0x20000
    s_add_u32 s16, s64, 0
    s_addc_u32 s17, s65, 0
    s_mov_b32 s18, 2621440
    s_mov_b32 s19, 0x20000
    s_and_b32 s26, s21, 1
    s_lshl_b32 s25, s25, 6
    s_add_u32 s25, s25, 65536
    v_add_u32 v244, s26, v12
    s_xor_b32 s26, s26, 1
    s_lshl_b32 s26, s26, 1
    v_mov_b32 v245, s26
    v_cmp_gt_u32 vcc, 2, v12
    v_lshl_add_u32 v246, v13, 2, s25
    s_nop 0
    v_cndmask_b32 v244, v245, v244, vcc
    v_lshl_add_u32 v244, v244, 6, v246
    s_mul_i32 s26, s23, 320
    s_add_u32 s26, s26, 12800
    v_lshl_add_u32 v248, v1, 2, s26
    v_lshl_add_u32 v249, v13, 2, s26
    s_lshl_b32 s80, s21, 10
    s_xor_b32 s81, s80, 1024
    s_xor_b32 s82, s80, 2048
    s_xor_b32 s83, s80, 3072
    s_mul_i32 s26, s21, 3
    s_add_u32 s26, s26, 1
    s_lshr_b32 s26, s26, 1
    s_mul_i32 s27, s23, 6
    s_add_u32 s26, s26, s27
    s_lshl_b32 s26, s26, 12
    s_lshr_b32 s30, s21, 1
    s_mul_i32 s31, s30, 3
    s_add_u32 s31, s31, 1
    s_add_u32 s27, s27, s31
    s_lshl_b32 s27, s27, 12
    s_add_u32 s72, s80, s26
    s_add_u32 s73, s81, s26
    s_add_u32 s74, s82, s26
    s_add_u32 s75, s83, s26
    s_add_u32 s76, s80, s27
    s_add_u32 s77, s82, s27
    s_and_b32 s26, s2, 7
    s_lshl_b32 s26, s26, 12
    s_add_u32 s26, s26, 196608
    v_and_b32 v123, 31, v1
    v_lshl_add_u32 v123, v123, 7, s26
    global_load_dword v122, v123, s[68:69] sc1
    s_mov_b32 s6, 0
    v_mov_b32 v16, -1
    v_mov_b32 v17, -1
    v_mov_b32 v18, -1
    v_mov_b32 v19, -1
    buffer_store_dwordx4 v[16:19], v8, s[12:15], s72 offen sc1
    buffer_store_dwordx4 v[16:19], v8, s[12:15], s73 offen sc1
    buffer_store_dwordx4 v[16:19], v8, s[12:15], s74 offen sc1
    buffer_store_dwordx4 v[16:19], v8, s[12:15], s75 offen sc1
    buffer_store_dwordx4 v[16:19], v8, s[12:15], s76 offen sc1
    buffer_store_dwordx4 v[16:19], v8, s[12:15], s77 offen sc1
    global_load_dword v250, v251, s[68:69] sc1
    s_waitcnt vmcnt(0)
    s_waitcnt vmcnt(0)
    v_cmp_gt_u32 vcc, 5, v122
    s_cbranch_vccnz LF_spinsmg
LF_gosmg:
LF_mlp:
    s_mov_b32 s71, 0
    s_barrier
    s_cmp_eq_u32 s21, 0
    s_cbranch_scc0 LF_m1
    s_lshr_b32 s26, s2, 3
    s_lshl_b32 s26, s26, 7
    s_add_u32 s26, s26, 163840
    v_lshl_add_u32 v12, v1, 12, s26
    v_mov_b32 v13, 1
    s_mov_b64 exec, 0xff
    global_atomic_add v12, v13, s[68:69] sc1
    s_mov_b64 exec, -1
LF_m1:
    s_mov_b32 s92, 0
    s_cmp_eq_u32 s6, 0
    s_cbranch_scc0 LF_w1ok
    v_cmp_gt_u32 vcc, 1, v250
    s_cbranch_vccnz LF_spinf1
LF_gof1:
    s_mov_b32 s6, 61440
    s_mov_b32 s28, 0
    buffer_load_dwordx4 a[0:3], v8, s[4:7], s28 offen offset:0 sc1
    buffer_load_dwordx4 a[4:7], v8, s[4:7], s28 offen offset:1024 sc1
    buffer_load_dwordx4 a[8:11], v8, s[4:7], s28 offen offset:2048 sc1
    buffer_load_dwordx4 a[12:15], v8, s[4:7], s28 offen offset:3072 sc1
    s_mov_b32 s28, 4096
    buffer_load_dwordx4 a[16:19], v8, s[4:7], s28 offen offset:0 sc1
    buffer_load_dwordx4 a[20:23], v8, s[4:7], s28 offen offset:1024 sc1
    buffer_load_dwordx4 a[24:27], v8, s[4:7], s28 offen offset:2048 sc1
    buffer_load_dwordx4 a[28:31], v8, s[4:7], s28 offen offset:3072 sc1
    s_mov_b32 s28, 8192
    buffer_load_dwordx4 a[32:35], v8, s[4:7], s28 offen offset:0 sc1
    buffer_load_dwordx4 a[36:39], v8, s[4:7], s28 offen offset:1024 sc1
    buffer_load_dwordx4 a[40:43], v8, s[4:7], s28 offen offset:2048 sc1
    buffer_load_dwordx4 a[44:47], v8, s[4:7], s28 offen offset:3072 sc1
    s_mov_b32 s28, 12288
    buffer_load_dwordx4 a[48:51], v8, s[4:7], s28 offen offset:0 sc1
    buffer_load_dwordx4 a[52:55], v8, s[4:7], s28 offen offset:1024 sc1
    buffer_load_dwordx4 a[56:59], v8, s[4:7], s28 offen offset:2048 sc1
    buffer_load_dwordx4 a[60:63], v8, s[4:7], s28 offen offset:3072 sc1
    s_mov_b32 s28, 16384
    buffer_load_dwordx4 a[64:67], v8, s[4:7], s28 offen offset:0 sc1
    buffer_load_dwordx4 a[68:71], v8, s[4:7], s28 offen offset:1024 sc1
    buffer_load_dwordx4 a[72:75], v8, s[4:7], s28 offen offset:2048 sc1
    buffer_load_dwordx4 a[76:79], v8, s[4:7], s28 offen offset:3072 sc1
LF_w1ok:
    global_load_dword v48, v248, s[68:69] sc1
    global_load_dword v49, v249, s[68:69] offset:256 sc1
    v_add_u32 v248, 15360, v248
    v_add_u32 v249, 15360, v249
    global_load_dword v50, v248, s[68:69] sc1
    global_load_dword v51, v249, s[68:69] offset:256 sc1
    v_add_u32 v248, 15360, v248
    v_add_u32 v249, 15360, v249
    global_load_dword v52, v248, s[68:69] sc1
    global_load_dword v53, v249, s[68:69] offset:256 sc1
    v_add_u32 v248, 15360, v248
    v_add_u32 v249, 15360, v249
    global_load_dword v54, v248, s[68:69] sc1
    global_load_dword v55, v249, s[68:69] offset:256 sc1
    global_load_dword v56, v244, s[68:69] sc1
    v_add_u32 v244, 6144, v244
    global_load_dword v57, v244, s[68:69] sc1
    v_add_u32 v244, 6144, v244
    global_load_dword v58, v244, s[68:69] sc1
    v_add_u32 v244, 6144, v244
    global_load_dword v59, v244, s[68:69] sc1
    v_add_u32 v244, 6144, v244
    global_load_dword v60, v244, s[68:69] sc1
    v_add_u32 v244, 6144, v244
    global_load_dword v61, v244, s[68:69] sc1
    v_add_u32 v244, 6144, v244
    global_load_dword v62, v244, s[68:69] sc1
    v_add_u32 v244, 6144, v244
    global_load_dword v63, v244, s[68:69] sc1
    v_lshrrev_b32 v14, 4, v1
    v_bfe_u32 v12, v1, 2, 2
    v_and_b32 v13, 1, v14
    v_lshl_add_u32 v15, v13, 2, v12
    v_lshrrev_b32 v13, 1, v14
    v_lshl_add_u32 v13, v13, 4, v15
    v_lshlrev_b32 v13, 7, v13
    v_and_b32 v12, 1, v1
    s_mov_b32 s28, 20480
    buffer_load_dwordx4 a[80:83], v8, s[4:7], s28 offen offset:0 sc1
    v_lshl_add_u32 v13, v12, 3, v13
    v_bfe_u32 v12, v1, 1, 1
    v_lshl_add_u32 v13, v12, 4, v13
    v_and_b32 v15, 6, v15
    s_xor_b32 s26, s21, 0
    s_lshl_b32 s26, s26, 1
    v_xor_b32 v12, s26, v15
    buffer_load_dwordx4 a[84:87], v8, s[4:7], s28 offen offset:1024 sc1
    v_lshl_add_u32 v236, v12, 4, v13
    v_add_u32 v240, 40960, v236
    s_xor_b32 s26, s21, 1
    s_lshl_b32 s26, s26, 1
    v_xor_b32 v12, s26, v15
    v_lshl_add_u32 v237, v12, 4, v13
    v_add_u32 v241, 40960, v237
    s_xor_b32 s26, s21, 2
    buffer_load_dwordx4 a[88:91], v8, s[4:7], s28 offen offset:2048 sc1
    s_lshl_b32 s26, s26, 1
    v_xor_b32 v12, s26, v15
    v_lshl_add_u32 v238, v12, 4, v13
    v_add_u32 v242, 40960, v238
    s_xor_b32 s26, s21, 3
    s_lshl_b32 s26, s26, 1
    v_xor_b32 v12, s26, v15
    buffer_load_dwordx4 a[92:95], v8, s[4:7], s28 offen offset:3072 sc1
    v_lshl_add_u32 v239, v12, 4, v13
    v_add_u32 v243, 40960, v239
    v_lshrrev_b32 v12, 3, v1
    v_and_b32 v13, 6, v12
    v_and_b32 v15, 7, v1
    v_xor_b32 v13, v13, v15
    v_lshlrev_b32 v12, 12, v12
    v_lshl_add_u32 v3, v13, 4, v12
    s_mov_b32 s28, 24576
    buffer_load_dwordx4 a[96:99], v8, s[4:7], s28 offen offset:0 sc1
    s_lshl_b32 s26, s21, 15
    s_lshl_b32 s27, s22, 7
    s_add_u32 s26, s26, s27
    s_add_u32 s26, s26, 10485760
    v_add_u32 v3, s26, v3
    s_lshl_b32 s26, s21, 10
    s_mov_b32 m0, s26
    buffer_load_dwordx4 a[100:103], v8, s[4:7], s28 offen offset:1024 sc1
    v_mov_b32 v232, 0x3f803f80
    v_mov_b32 v233, 0x3f803f80
    v_mov_b32 v234, 0x3f803f80
    v_mov_b32 v235, 0x3f803f80
    s_lshr_b32 s30, s21, 1
    s_lshl_b32 s30, s30, 12
    s_add_u32 s30, s30, 81920
    buffer_load_dwordx4 a[104:107], v8, s[4:7], s28 offen offset:2048 sc1
    s_and_b32 s31, s21, 1
    s_lshl_b32 s31, s31, 3
    v_add_u32 v244, s30, v8
    v_add_u32 v245, s31, v244
    s_lshl_b32 s26, s22, 9
    s_add_u32 s26, s26, 245760
    s_lshr_b32 s27, s23, 1
    s_lshl_b32 s27, s27, 7
    buffer_load_dwordx4 a[108:111], v8, s[4:7], s28 offen offset:3072 sc1
    s_and_b32 s30, s23, 1
    s_lshl_b32 s30, s30, 4
    s_add_u32 s27, s27, s30
    s_lshl_b32 s30, s21, 2
    s_add_u32 s27, s27, s30
    s_add_u32 s27, s27, s26
    v_mov_b32 v10, s27
    s_mov_b32 s28, 28672
    buffer_load_dwordx4 a[112:115], v8, s[4:7], s28 offen offset:0 sc1
    s_lshl_b32 s30, s21, 7
    s_add_u32 s26, s26, s30
    v_and_b32 v11, 7, v1
    v_lshl_add_u32 v11, v11, 2, s26
    s_mul_i32 s78, s21, 49152
    v_and_b32 v9, 15, v1
    v_lshlrev_b32 v9, 3, v9
    s_lshl_b32 s26, s21, 7
    buffer_load_dwordx4 a[116:119], v8, s[4:7], s28 offen offset:1024 sc1
    s_add_u32 s26, s26, 143360
    v_add_u32 v9, s26, v9
    v_and_b32 v13, 3, v1
    v_cmp_eq_u32 s[84:85], 1, v13
    v_cmp_eq_u32 s[86:87], 2, v13
    v_cmp_eq_u32 s[88:89], 3, v13
    v_bfe_u32 v15, v1, 2, 2
    buffer_load_dwordx4 a[120:123], v8, s[4:7], s28 offen offset:2048 sc1
    v_cmp_eq_u32 s[90:91], v14, v15
    v_add_u32 v4, s80, v8
    v_add_u32 v5, s81, v8
    v_add_u32 v6, s82, v8
    v_add_u32 v7, s83, v8
    s_lshl_b32 s26, s21, 1
    v_lshrrev_b32 v12, 4, v1
    buffer_load_dwordx4 a[124:127], v8, s[4:7], s28 offen offset:3072 sc1
    v_bfe_u32 v13, v1, 2, 2
    v_lshl_add_u32 v13, v12, 2, v13
    v_and_b32 v16, 6, v13
    v_xor_b32 v16, s26, v16
    v_bfe_u32 v17, v1, 1, 1
    v_add_u32 v16, v16, v17
    v_lshlrev_b32 v16, 4, v16
    v_lshl_add_u32 v16, v13, 7, v16
    s_mov_b32 s28, 32768
    buffer_load_dwordx4 a[128:131], v8, s[4:7], s28 offen offset:0 sc1
    v_and_b32 v17, 1, v1
    v_lshl_add_u32 v16, v17, 3, v16
    s_mul_i32 s26, s23, 10240
    v_add_u32 v16, s26, v16
    s_mul_i32 s93, s21, 15360
    s_add_u32 s93, s93, 81920
    v_and_b32 v17, 15, v1
    buffer_load_dwordx4 a[132:135], v8, s[4:7], s28 offen offset:1024 sc1
    v_mul_u32_u24 v17, 176, v17
    v_lshl_add_u32 v17, v12, 3, v17
    v_add_u32 v17, s93, v17
    v_add_u32 v18, s93, v8
    s_mul_i32 s26, s21, 320
    s_add_u32 s26, s26, 143872
    v_lshl_add_u32 v22, v12, 4, s26
    s_lshr_b32 s26, s22, 3
    buffer_load_dwordx4 a[136:139], v8, s[4:7], s28 offen offset:2048 sc1
    s_lshl_b32 s26, s26, 9
    s_and_b32 s27, s22, 1
    s_lshl_b32 s27, s27, 7
    s_add_u32 s26, s26, s27
    s_bfe_u32 s27, s22, 0x20001
    s_lshl_b32 s27, s27, 2
    s_add_u32 s26, s26, s27
    buffer_load_dwordx4 a[140:143], v8, s[4:7], s28 offen offset:3072 sc1
    s_lshl_b32 s27, s21, 5
    s_add_u32 s26, s26, s27
    s_mul_i32 s26, s26, 1280
    s_mul_i32 s27, s23, 160
    s_add_u32 s94, s26, s27
    v_add_u32 v23, 0, v1
    v_mul_u32_u24 v2, 6554, v23
    s_mov_b32 s28, 36864
    buffer_load_dwordx4 a[144:147], v8, s[4:7], s28 offen offset:0 sc1
    v_lshrrev_b32 v2, 16, v2
    v_mul_u32_u24 v12, 10, v2
    v_sub_u32 v23, v23, v12
    v_mul_u32_u24 v12, 176, v2
    v_lshl_add_u32 v12, v23, 4, v12
    v_add_u32 v19, s93, v12
    v_bfe_u32 v12, v2, 2, 1
    v_lshlrev_b32 v12, 8, v12
    buffer_load_dwordx4 a[148:151], v8, s[4:7], s28 offen offset:1024 sc1
    v_bfe_u32 v13, v2, 3, 1
    v_lshl_add_u32 v12, v13, 4, v12
    v_and_b32 v13, 3, v2
    v_add_u32 v12, v12, v13
    v_mul_u32_u24 v12, 1280, v12
    v_lshl_add_u32 v252, v23, 4, v12
    v_add_u32 v23, 64, v1
    buffer_load_dwordx4 a[152:155], v8, s[4:7], s28 offen offset:2048 sc1
    v_mul_u32_u24 v2, 6554, v23
    v_lshrrev_b32 v2, 16, v2
    v_mul_u32_u24 v12, 10, v2
    v_sub_u32 v23, v23, v12
    v_mul_u32_u24 v12, 176, v2
    v_lshl_add_u32 v12, v23, 4, v12
    v_add_u32 v20, s93, v12
    v_bfe_u32 v12, v2, 2, 1
    buffer_load_dwordx4 a[156:159], v8, s[4:7], s28 offen offset:3072 sc1
    v_lshlrev_b32 v12, 8, v12
    v_bfe_u32 v13, v2, 3, 1
    v_lshl_add_u32 v12, v13, 4, v12
    v_and_b32 v13, 3, v2
    v_add_u32 v12, v12, v13
    v_mul_u32_u24 v12, 1280, v12
    v_lshl_add_u32 v253, v23, 4, v12
    s_mov_b32 s28, 53248
    buffer_load_dwordx4 a[216:219], v8, s[4:7], s28 offen offset:2048 sc1
    v_add_u32 v23, 128, v1
    v_mul_u32_u24 v2, 6554, v23
    v_lshrrev_b32 v2, 16, v2
    v_mul_u32_u24 v12, 10, v2
    v_sub_u32 v23, v23, v12
    v_mul_u32_u24 v12, 176, v2
    v_lshl_add_u32 v12, v23, 4, v12
    buffer_load_dwordx4 a[220:223], v8, s[4:7], s28 offen offset:3072 sc1
    v_add_u32 v21, s93, v12
    v_bfe_u32 v12, v2, 2, 1
    v_lshlrev_b32 v12, 8, v12
    v_bfe_u32 v13, v2, 3, 1
    v_lshl_add_u32 v12, v13, 4, v12
    v_and_b32 v13, 3, v2
    v_add_u32 v12, v12, v13
    v_mul_u32_u24 v12, 1280, v12
    s_mov_b32 s28, 57344
    buffer_load_dwordx4 a[224:227], v8, s[4:7], s28 offen offset:0 sc1
    v_lshl_add_u32 v254, v23, 4, v12
    v_lshrrev_b32 v2, 5, v1
    v_lshlrev_b32 v2, 30, v2
    v_add_u32 v254, v254, v2
    v_accvgpr_write_b32 a240, v16
    v_accvgpr_write_b32 a241, v17
    v_accvgpr_write_b32 a242, v18
    buffer_load_dwordx4 a[228:231], v8, s[4:7], s28 offen offset:1024 sc1
    v_accvgpr_write_b32 a243, v19
    v_accvgpr_write_b32 a244, v20
    v_accvgpr_write_b32 a245, v21
    v_accvgpr_write_b32 a246, v22
    v_accvgpr_write_b32 a247, v252
    v_accvgpr_write_b32 a248, v253
    v_accvgpr_write_b32 a249, v254
    s_xor_b32 s26, s21, 1
    buffer_load_dwordx4 a[232:235], v8, s[4:7], s28 offen offset:2048 sc1
    s_mul_i32 s26, s26, 15360
    s_add_u32 s26, s26, 81920
    v_add_u32 v16, s26, v8
    s_xor_b32 s26, s21, 2
    s_mul_i32 s26, s26, 15360
    s_add_u32 s26, s26, 87040
    v_add_u32 v17, s26, v8
    buffer_load_dwordx4 a[236:239], v8, s[4:7], s28 offen offset:3072 sc1
    s_xor_b32 s26, s21, 3
    s_mul_i32 s26, s26, 15360
    s_add_u32 s26, s26, 92160
    v_add_u32 v18, s26, v8
    v_accvgpr_write_b32 a250, v16
    v_accvgpr_write_b32 a251, v17
    v_accvgpr_write_b32 a252, v18
    s_mul_i32 s26, s21, 320
    s_add_u32 s26, s26, 143872
    v_lshl_add_u32 v66, v1, 2, s26
    v_and_b32 v67, 15, v1
    v_lshl_add_u32 v67, v67, 2, s26
    s_lshl_b32 s26, s21, 9
    s_add_u32 s26, s26, 145152
    v_lshl_add_u32 v69, v1, 2, s26
    v_lshrrev_b32 v68, 4, v1
    v_lshl_add_u32 v68, v68, 4, s26
    s_waitcnt vmcnt(26)
    v_pk_add_f32 v[56:57], v[56:57], v[58:59]
    v_pk_add_f32 v[60:61], v[60:61], v[62:63]
    v_pk_add_f32 v[56:57], v[56:57], v[60:61]
    v_mul_f32 v57, 3216550459, v57
    s_mov_b32 s28, 40960
    buffer_load_dwordx4 a[160:163], v8, s[4:7], s28 offen offset:0 sc1
    ds_write_b32 v69, v56
    ds_write_b32 v69, v57 offset:256
    ds_read_b128 v[24:27], v68
    buffer_load_dwordx4 a[164:167], v8, s[4:7], s28 offen offset:1024 sc1
    ds_read_b128 v[28:31], v68 offset:256
    ds_read_b128 v[32:35], v68 offset:64
    ds_read_b128 v[36:39], v68 offset:320
    buffer_load_dwordx4 a[168:171], v8, s[4:7], s28 offen offset:2048 sc1
    ds_read_b128 v[40:43], v68 offset:128
    ds_read_b128 v[44:47], v68 offset:384
    v_pk_add_f32 v[48:49], v[48:49], v[50:51]
    buffer_load_dwordx4 a[172:175], v8, s[4:7], s28 offen offset:3072 sc1
    v_pk_add_f32 v[52:53], v[52:53], v[54:55]
    v_pk_add_f32 v[48:49], v[48:49], v[52:53]
    v_cvt_pk_bf16_f32 v48, v48, v49
    s_mov_b32 s28, 45056
    buffer_load_dwordx4 a[176:179], v8, s[4:7], s28 offen offset:0 sc1
    v_and_b32 v49, 0xffff0000, v48
    v_lshlrev_b32 v48, 16, v48
    v_mul_f32 v48, 3207688728, v48
    buffer_load_dwordx4 a[180:183], v8, s[4:7], s28 offen offset:1024 sc1
    v_mul_f32 v49, 3207688728, v49
    ds_write_b32 v66, v48
    ds_write_b32 v67, v49 offset:256
    s_cmp_eq_u32 s21, 0
    s_cbranch_scc0 LF_m2a
    s_and_b32 s26, s2, 7
    s_lshl_b32 s26, s26, 12
    s_add_u32 s26, s26, 163840
    v_and_b32 v13, 31, v1
    v_lshl_add_u32 v13, v13, 7, s26
    global_load_dword v12, v13, s[68:69] sc1
LF_m2a:
    buffer_load_dwordx4 a[184:187], v8, s[4:7], s28 offen offset:2048 sc1
    buffer_load_dwordx4 a[188:191], v8, s[4:7], s28 offen offset:3072 sc1
    s_mov_b32 s28, 49152
    buffer_load_dwordx4 a[192:195], v8, s[4:7], s28 offen offset:0 sc1
    buffer_load_dwordx4 a[196:199], v8, s[4:7], s28 offen offset:1024 sc1
    buffer_load_dwordx4 a[200:203], v8, s[4:7], s28 offen offset:2048 sc1
    buffer_load_dwordx4 a[204:207], v8, s[4:7], s28 offen offset:3072 sc1
    s_mov_b32 s28, 53248
    buffer_load_dwordx4 a[208:211], v8, s[4:7], s28 offen offset:0 sc1
    buffer_load_dwordx4 a[212:215], v8, s[4:7], s28 offen offset:1024 sc1
    s_cmp_eq_u32 s21, 0
    s_cbranch_scc0 LF_m2
    s_waitcnt vmcnt(8)
    v_cmp_gt_u32 vcc, 8, v12
    s_cbranch_vccnz LF_spins2
LF_gos2:
LF_m2:
    s_barrier
LF_x1:
    global_load_lds_dwordx4 v3, s[68:69] sc1
    s_add_u32 m0, m0, 4096
    v_add_u32 v3, 0x20000, v3
    global_load_lds_dwordx4 v3, s[68:69] sc1
    s_add_u32 m0, m0, 4096
    v_add_u32 v3, 0x20000, v3
    global_load_lds_dwordx4 v3, s[68:69] sc1
    s_add_u32 m0, m0, 4096
    v_add_u32 v3, 0x20000, v3
    global_load_lds_dwordx4 v3, s[68:69] sc1
    s_add_u32 m0, m0, 4096
    v_add_u32 v3, 0x20000, v3
    global_load_lds_dwordx4 v3, s[68:69] sc1
    s_add_u32 m0, m0, 4096
    v_add_u32 v3, 0x20000, v3
    global_load_lds_dwordx4 v3, s[68:69] sc1
    s_add_u32 m0, m0, 4096
    v_add_u32 v3, 0x20000, v3
    global_load_lds_dwordx4 v3, s[68:69] sc1
    s_add_u32 m0, m0, 4096
    v_add_u32 v3, 0x20000, v3
    global_load_lds_dwordx4 v3, s[68:69] sc1
    s_add_u32 m0, m0, 4096
    v_add_u32 v3, 0x20000, v3
    global_load_lds_dwordx4 v3, s[68:69] sc1
    s_add_u32 m0, m0, 4096
    v_add_u32 v3, 0x20000, v3
    global_load_lds_dwordx4 v3, s[68:69] sc1
    s_add_u32 m0, m0, 4096
    v_add_u32 v3, 0x20000, v3
    global_load_lds_dwordx4 v3, s[68:69] sc1
    s_add_u32 m0, m0, 4096
    v_add_u32 v3, 0x20000, v3
    global_load_lds_dwordx4 v3, s[68:69] sc1
    s_add_u32 m0, m0, 4096
    v_add_u32 v3, 0x20000, v3
    s_waitcnt vmcnt(9)
    s_barrier
    ds_read_b64_tr_b16 v[96:97], v236 offset:0
    ds_read_b64_tr_b16 v[98:99], v236 offset:1024
    ds_read_b64_tr_b16 v[100:101], v237 offset:0
    ds_read_b64_tr_b16 v[102:103], v237 offset:1024
    ds_read_b64_tr_b16 v[104:105], v238 offset:0
    ds_read_b64_tr_b16 v[106:107], v238 offset:1024
    ds_read_b64_tr_b16 v[108:109], v239 offset:0
    ds_read_b64_tr_b16 v[110:111], v239 offset:1024
    ds_read_b64_tr_b16 v[112:113], v236 offset:4096
    ds_read_b64_tr_b16 v[114:115], v236 offset:5120
    ds_read_b64_tr_b16 v[116:117], v237 offset:4096
    ds_read_b64_tr_b16 v[118:119], v237 offset:5120
    ds_read_b64_tr_b16 v[120:121], v238 offset:4096
    ds_read_b64_tr_b16 v[122:123], v238 offset:5120
    ds_read_b64_tr_b16 v[124:125], v239 offset:4096
    ds_read_b64_tr_b16 v[126:127], v239 offset:5120
    s_waitcnt lgkmcnt(14)
    v_mfma_f32_16x16x32_bf16 v[224:227], v[96:99], v[96:99], 0
    global_load_lds_dwordx4 v3, s[68:69] sc1
    s_add_u32 m0, m0, 4096
    v_add_u32 v3, 0x20000, v3
    v_mfma_f32_16x16x32_bf16 v[228:231], v[232:235], v[96:99], 0
    global_load_lds_dwordx4 v3, s[68:69] sc1
    s_add_u32 m0, m0, 4096
    v_add_u32 v3, 0x20000, v3
    v_mfma_f32_16x16x32_bf16 v[48:51], a[0:3], v[96:99], 0
    ds_read_b64_tr_b16 v[128:129], v236 offset:8192
    v_mfma_f32_16x16x32_bf16 v[64:67], a[4:7], v[96:99], 0
    ds_read_b64_tr_b16 v[130:131], v236 offset:9216
    s_waitcnt lgkmcnt(14)
    v_mfma_f32_16x16x32_bf16 v[52:55], a[0:3], v[100:103], 0
    ds_read_b64_tr_b16 v[132:133], v237 offset:8192
    v_mfma_f32_16x16x32_bf16 v[68:71], a[4:7], v[100:103], 0
    ds_read_b64_tr_b16 v[134:135], v237 offset:9216
    s_waitcnt lgkmcnt(14)
    v_mfma_f32_16x16x32_bf16 v[56:59], a[0:3], v[104:107], 0
    ds_read_b64_tr_b16 v[136:137], v238 offset:8192
    v_mfma_f32_16x16x32_bf16 v[72:75], a[4:7], v[104:107], 0
    ds_read_b64_tr_b16 v[138:139], v238 offset:9216
    s_waitcnt lgkmcnt(14)
    v_mfma_f32_16x16x32_bf16 v[60:63], a[0:3], v[108:111], 0
    ds_read_b64_tr_b16 v[140:141], v239 offset:8192
    v_mfma_f32_16x16x32_bf16 v[76:79], a[4:7], v[108:111], 0
    ds_read_b64_tr_b16 v[142:143], v239 offset:9216
    s_waitcnt vmcnt(5)
    s_barrier
    s_waitcnt lgkmcnt(14)
    v_mfma_f32_16x16x32_bf16 v[224:227], v[112:115], v[112:115], v[224:227]
    global_load_lds_dwordx4 v3, s[68:69] sc1
    s_add_u32 m0, m0, 4096
    v_add_u32 v3, 0x20000, v3
    v_mfma_f32_16x16x32_bf16 v[228:231], v[232:235], v[112:115], v[228:231]
    global_load_lds_dwordx4 v3, s[68:69] sc1
    s_add_u32 m0, m0, 4096
    v_add_u32 v3, 0x20000, v3
    v_mfma_f32_16x16x32_bf16 v[48:51], a[8:11], v[112:115], v[48:51]
    ds_read_b64_tr_b16 v[144:145], v236 offset:12288
    v_mfma_f32_16x16x32_bf16 v[64:67], a[12:15], v[112:115], v[64:67]
    ds_read_b64_tr_b16 v[146:147], v236 offset:13312
    s_waitcnt lgkmcnt(14)
    v_mfma_f32_16x16x32_bf16 v[52:55], a[8:11], v[116:119], v[52:55]
    ds_read_b64_tr_b16 v[148:149], v237 offset:12288
    v_mfma_f32_16x16x32_bf16 v[68:71], a[12:15], v[116:119], v[68:71]
    ds_read_b64_tr_b16 v[150:151], v237 offset:13312
    s_waitcnt lgkmcnt(14)
    v_mfma_f32_16x16x32_bf16 v[56:59], a[8:11], v[120:123], v[56:59]
    ds_read_b64_tr_b16 v[152:153], v238 offset:12288
    v_mfma_f32_16x16x32_bf16 v[72:75], a[12:15], v[120:123], v[72:75]
    ds_read_b64_tr_b16 v[154:155], v238 offset:13312
    s_waitcnt lgkmcnt(14)
    v_mfma_f32_16x16x32_bf16 v[60:63], a[8:11], v[124:127], v[60:63]
    ds_read_b64_tr_b16 v[156:157], v239 offset:12288
    v_mfma_f32_16x16x32_bf16 v[76:79], a[12:15], v[124:127], v[76:79]
    ds_read_b64_tr_b16 v[158:159], v239 offset:13312
    s_waitcnt lgkmcnt(14)
    v_mfma_f32_16x16x32_bf16 v[224:227], v[128:131], v[128:131], v[224:227]
    global_load_lds_dwordx4 v3, s[68:69] sc1
    s_add_u32 m0, m0, 4096
    v_add_u32 v3, 0x20000, v3
    v_mfma_f32_16x16x32_bf16 v[228:231], v[232:235], v[128:131], v[228:231]
    global_load_lds_dwordx4 v3, s[68:69] sc1
    s_add_u32 m0, m0, 4096
    v_add_u32 v3, 0x20000, v3
    v_mfma_f32_16x16x32_bf16 v[48:51], a[16:19], v[128:131], v[48:51]
    ds_read_b64_tr_b16 v[160:161], v236 offset:16384
    v_mfma_f32_16x16x32_bf16 v[64:67], a[20:23], v[128:131], v[64:67]
    ds_read_b64_tr_b16 v[162:163], v236 offset:17408
    s_waitcnt lgkmcnt(14)
    v_mfma_f32_16x16x32_bf16 v[52:55], a[16:19], v[132:135], v[52:55]
    ds_read_b64_tr_b16 v[164:165], v237 offset:16384
    v_mfma_f32_16x16x32_bf16 v[68:71], a[20:23], v[132:135], v[68:71]
    ds_read_b64_tr_b16 v[166:167], v237 offset:17408
    s_waitcnt lgkmcnt(14)
    v_mfma_f32_16x16x32_bf16 v[56:59], a[16:19], v[136:139], v[56:59]
    ds_read_b64_tr_b16 v[168:169], v238 offset:16384
    v_mfma_f32_16x16x32_bf16 v[72:75], a[20:23], v[136:139], v[72:75]
    ds_read_b64_tr_b16 v[170:171], v238 offset:17408
    s_waitcnt lgkmcnt(14)
    v_mfma_f32_16x16x32_bf16 v[60:63], a[16:19], v[140:143], v[60:63]
    ds_read_b64_tr_b16 v[172:173], v239 offset:16384
    v_mfma_f32_16x16x32_bf16 v[76:79], a[20:23], v[140:143], v[76:79]
    ds_read_b64_tr_b16 v[174:175], v239 offset:17408
    s_waitcnt lgkmcnt(14)
    v_mfma_f32_16x16x32_bf16 v[224:227], v[144:147], v[144:147], v[224:227]
    global_load_lds_dwordx4 v3, s[68:69] sc1
    s_add_u32 m0, m0, 4096
    v_add_u32 v3, 0x20000, v3
    v_mfma_f32_16x16x32_bf16 v[228:231], v[232:235], v[144:147], v[228:231]
    global_load_lds_dwordx4 v3, s[68:69] sc1
    v_mfma_f32_16x16x32_bf16 v[48:51], a[24:27], v[144:147], v[48:51]
    ds_read_b64_tr_b16 v[176:177], v236 offset:20480
    v_mfma_f32_16x16x32_bf16 v[64:67], a[28:31], v[144:147], v[64:67]
    ds_read_b64_tr_b16 v[178:179], v236 offset:21504
    s_waitcnt lgkmcnt(14)
    v_mfma_f32_16x16x32_bf16 v[52:55], a[24:27], v[148:151], v[52:55]
    ds_read_b64_tr_b16 v[180:181], v237 offset:20480
    v_mfma_f32_16x16x32_bf16 v[68:71], a[28:31], v[148:151], v[68:71]
    ds_read_b64_tr_b16 v[182:183], v237 offset:21504
    s_waitcnt lgkmcnt(14)
    v_mfma_f32_16x16x32_bf16 v[56:59], a[24:27], v[152:155], v[56:59]
    ds_read_b64_tr_b16 v[184:185], v238 offset:20480
    v_mfma_f32_16x16x32_bf16 v[72:75], a[28:31], v[152:155], v[72:75]
    ds_read_b64_tr_b16 v[186:187], v238 offset:21504
    s_waitcnt lgkmcnt(14)
    v_mfma_f32_16x16x32_bf16 v[60:63], a[24:27], v[156:159], v[60:63]
    ds_read_b64_tr_b16 v[188:189], v239 offset:20480
    v_mfma_f32_16x16x32_bf16 v[76:79], a[28:31], v[156:159], v[76:79]
    ds_read_b64_tr_b16 v[190:191], v239 offset:21504
    s_waitcnt lgkmcnt(14)
    v_mfma_f32_16x16x32_bf16 v[224:227], v[160:163], v[160:163], v[224:227]
    s_mov_b32 s29, 0
    buffer_load_dwordx4 a[0:3], v8, s[8:11], s29 offen offset:0 sc1
    v_mfma_f32_16x16x32_bf16 v[228:231], v[232:235], v[160:163], v[228:231]
    buffer_load_dwordx4 a[4:7], v8, s[8:11], s29 offen offset:1024 sc1
    v_mfma_f32_16x16x32_bf16 v[48:51], a[32:35], v[160:163], v[48:51]
    ds_read_b64_tr_b16 v[96:97], v236 offset:24576
    v_mfma_f32_16x16x32_bf16 v[64:67], a[36:39], v[160:163], v[64:67]
    ds_read_b64_tr_b16 v[98:99], v236 offset:25600
    s_waitcnt lgkmcnt(14)
    v_mfma_f32_16x16x32_bf16 v[52:55], a[32:35], v[164:167], v[52:55]
    ds_read_b64_tr_b16 v[100:101], v237 offset:24576
    v_mfma_f32_16x16x32_bf16 v[68:71], a[36:39], v[164:167], v[68:71]
    ds_read_b64_tr_b16 v[102:103], v237 offset:25600
    s_waitcnt lgkmcnt(14)
    v_mfma_f32_16x16x32_bf16 v[56:59], a[32:35], v[168:171], v[56:59]
    ds_read_b64_tr_b16 v[104:105], v238 offset:24576
    v_mfma_f32_16x16x32_bf16 v[72:75], a[36:39], v[168:171], v[72:75]
    ds_read_b64_tr_b16 v[106:107], v238 offset:25600
    s_waitcnt lgkmcnt(14)
    v_mfma_f32_16x16x32_bf16 v[60:63], a[32:35], v[172:175], v[60:63]
    ds_read_b64_tr_b16 v[108:109], v239 offset:24576
    v_mfma_f32_16x16x32_bf16 v[76:79], a[36:39], v[172:175], v[76:79]
    ds_read_b64_tr_b16 v[110:111], v239 offset:25600
    s_waitcnt lgkmcnt(14)
    v_mfma_f32_16x16x32_bf16 v[224:227], v[176:179], v[176:179], v[224:227]
    buffer_load_dwordx4 a[8:11], v8, s[8:11], s29 offen offset:2048 sc1
    v_mfma_f32_16x16x32_bf16 v[228:231], v[232:235], v[176:179], v[228:231]
    buffer_load_dwordx4 a[12:15], v8, s[8:11], s29 offen offset:3072 sc1
    v_mfma_f32_16x16x32_bf16 v[48:51], a[40:43], v[176:179], v[48:51]
    ds_read_b64_tr_b16 v[112:113], v236 offset:28672
    v_mfma_f32_16x16x32_bf16 v[64:67], a[44:47], v[176:179], v[64:67]
    ds_read_b64_tr_b16 v[114:115], v236 offset:29696
    s_waitcnt lgkmcnt(14)
    v_mfma_f32_16x16x32_bf16 v[52:55], a[40:43], v[180:183], v[52:55]
    ds_read_b64_tr_b16 v[116:117], v237 offset:28672
    v_mfma_f32_16x16x32_bf16 v[68:71], a[44:47], v[180:183], v[68:71]
    ds_read_b64_tr_b16 v[118:119], v237 offset:29696
    s_waitcnt lgkmcnt(14)
    v_mfma_f32_16x16x32_bf16 v[56:59], a[40:43], v[184:187], v[56:59]
    ds_read_b64_tr_b16 v[120:121], v238 offset:28672
    v_mfma_f32_16x16x32_bf16 v[72:75], a[44:47], v[184:187], v[72:75]
    ds_read_b64_tr_b16 v[122:123], v238 offset:29696
    s_waitcnt lgkmcnt(14)
    v_mfma_f32_16x16x32_bf16 v[60:63], a[40:43], v[188:191], v[60:63]
    ds_read_b64_tr_b16 v[124:125], v239 offset:28672
    v_mfma_f32_16x16x32_bf16 v[76:79], a[44:47], v[188:191], v[76:79]
    ds_read_b64_tr_b16 v[126:127], v239 offset:29696
    s_waitcnt lgkmcnt(14)
    v_mfma_f32_16x16x32_bf16 v[224:227], v[96:99], v[96:99], v[224:227]
    s_mov_b32 s29, 4096
    buffer_load_dwordx4 a[16:19], v8, s[8:11], s29 offen offset:0 sc1
    v_mfma_f32_16x16x32_bf16 v[228:231], v[232:235], v[96:99], v[228:231]
    buffer_load_dwordx4 a[20:23], v8, s[8:11], s29 offen offset:1024 sc1
    v_mfma_f32_16x16x32_bf16 v[48:51], a[48:51], v[96:99], v[48:51]
    ds_read_b64_tr_b16 v[128:129], v236 offset:32768
    v_mfma_f32_16x16x32_bf16 v[64:67], a[52:55], v[96:99], v[64:67]
    ds_read_b64_tr_b16 v[130:131], v236 offset:33792
    s_waitcnt lgkmcnt(14)
    v_mfma_f32_16x16x32_bf16 v[52:55], a[48:51], v[100:103], v[52:55]
    ds_read_b64_tr_b16 v[132:133], v237 offset:32768
    v_mfma_f32_16x16x32_bf16 v[68:71], a[52:55], v[100:103], v[68:71]
    ds_read_b64_tr_b16 v[134:135], v237 offset:33792
    s_waitcnt lgkmcnt(14)
    v_mfma_f32_16x16x32_bf16 v[56:59], a[48:51], v[104:107], v[56:59]
    ds_read_b64_tr_b16 v[136:137], v238 offset:32768
    v_mfma_f32_16x16x32_bf16 v[72:75], a[52:55], v[104:107], v[72:75]
    ds_read_b64_tr_b16 v[138:139], v238 offset:33792
    s_waitcnt lgkmcnt(14)
    v_mfma_f32_16x16x32_bf16 v[60:63], a[48:51], v[108:111], v[60:63]
    ds_read_b64_tr_b16 v[140:141], v239 offset:32768
    v_mfma_f32_16x16x32_bf16 v[76:79], a[52:55], v[108:111], v[76:79]
    ds_read_b64_tr_b16 v[142:143], v239 offset:33792
    s_waitcnt vmcnt(6)
    s_barrier
    s_waitcnt lgkmcnt(14)
    v_mfma_f32_16x16x32_bf16 v[224:227], v[112:115], v[112:115], v[224:227]
    buffer_load_dwordx4 a[24:27], v8, s[8:11], s29 offen offset:2048 sc1
    v_mfma_f32_16x16x32_bf16 v[228:231], v[232:235], v[112:115], v[228:231]
    buffer_load_dwordx4 a[28:31], v8, s[8:11], s29 offen offset:3072 sc1
    v_mfma_f32_16x16x32_bf16 v[48:51], a[56:59], v[112:115], v[48:51]
    ds_read_b64_tr_b16 v[144:145], v236 offset:36864
    v_mfma_f32_16x16x32_bf16 v[64:67], a[60:63], v[112:115], v[64:67]
    ds_read_b64_tr_b16 v[146:147], v236 offset:37888
    s_waitcnt lgkmcnt(14)
    v_mfma_f32_16x16x32_bf16 v[52:55], a[56:59], v[116:119], v[52:55]
    ds_read_b64_tr_b16 v[148:149], v237 offset:36864
    v_mfma_f32_16x16x32_bf16 v[68:71], a[60:63], v[116:119], v[68:71]
    ds_read_b64_tr_b16 v[150:151], v237 offset:37888
    s_waitcnt lgkmcnt(14)
    v_mfma_f32_16x16x32_bf16 v[56:59], a[56:59], v[120:123], v[56:59]
    ds_read_b64_tr_b16 v[152:153], v238 offset:36864
    v_mfma_f32_16x16x32_bf16 v[72:75], a[60:63], v[120:123], v[72:75]
    ds_read_b64_tr_b16 v[154:155], v238 offset:37888
    s_waitcnt lgkmcnt(14)
    v_mfma_f32_16x16x32_bf16 v[60:63], a[56:59], v[124:127], v[60:63]
    ds_read_b64_tr_b16 v[156:157], v239 offset:36864
    v_mfma_f32_16x16x32_bf16 v[76:79], a[60:63], v[124:127], v[76:79]
    ds_read_b64_tr_b16 v[158:159], v239 offset:37888
    s_waitcnt lgkmcnt(14)
    v_mfma_f32_16x16x32_bf16 v[224:227], v[128:131], v[128:131], v[224:227]
    s_mov_b32 s29, 8192
    buffer_load_dwordx4 a[32:35], v8, s[8:11], s29 offen offset:0 sc1
    v_mfma_f32_16x16x32_bf16 v[228:231], v[232:235], v[128:131], v[228:231]
    buffer_load_dwordx4 a[36:39], v8, s[8:11], s29 offen offset:1024 sc1
    v_mfma_f32_16x16x32_bf16 v[48:51], a[64:67], v[128:131], v[48:51]
    ds_read_b64_tr_b16 v[160:161], v240 offset:0
    v_mfma_f32_16x16x32_bf16 v[64:67], a[68:71], v[128:131], v[64:67]
    ds_read_b64_tr_b16 v[162:163], v240 offset:1024
    s_waitcnt lgkmcnt(14)
    v_mfma_f32_16x16x32_bf16 v[52:55], a[64:67], v[132:135], v[52:55]
    ds_read_b64_tr_b16 v[164:165], v241 offset:0
    v_mfma_f32_16x16x32_bf16 v[68:71], a[68:71], v[132:135], v[68:71]
    ds_read_b64_tr_b16 v[166:167], v241 offset:1024
    s_waitcnt lgkmcnt(14)
    v_mfma_f32_16x16x32_bf16 v[56:59], a[64:67], v[136:139], v[56:59]
    ds_read_b64_tr_b16 v[168:169], v242 offset:0
    v_mfma_f32_16x16x32_bf16 v[72:75], a[68:71], v[136:139], v[72:75]
    ds_read_b64_tr_b16 v[170:171], v242 offset:1024
    s_waitcnt lgkmcnt(14)
    v_mfma_f32_16x16x32_bf16 v[60:63], a[64:67], v[140:143], v[60:63]
    ds_read_b64_tr_b16 v[172:173], v243 offset:0
    v_mfma_f32_16x16x32_bf16 v[76:79], a[68:71], v[140:143], v[76:79]
    ds_read_b64_tr_b16 v[174:175], v243 offset:1024
    s_waitcnt lgkmcnt(14)
    v_mfma_f32_16x16x32_bf16 v[224:227], v[144:147], v[144:147], v[224:227]
    buffer_load_dwordx4 a[40:43], v8, s[8:11], s29 offen offset:2048 sc1
    v_mfma_f32_16x16x32_bf16 v[228:231], v[232:235], v[144:147], v[228:231]
    buffer_load_dwordx4 a[44:47], v8, s[8:11], s29 offen offset:3072 sc1
    v_mfma_f32_16x16x32_bf16 v[48:51], a[72:75], v[144:147], v[48:51]
    ds_read_b64_tr_b16 v[176:177], v240 offset:4096
    v_mfma_f32_16x16x32_bf16 v[64:67], a[76:79], v[144:147], v[64:67]
    ds_read_b64_tr_b16 v[178:179], v240 offset:5120
    s_waitcnt lgkmcnt(14)
    v_mfma_f32_16x16x32_bf16 v[52:55], a[72:75], v[148:151], v[52:55]
    ds_read_b64_tr_b16 v[180:181], v241 offset:4096
    v_mfma_f32_16x16x32_bf16 v[68:71], a[76:79], v[148:151], v[68:71]
    ds_read_b64_tr_b16 v[182:183], v241 offset:5120
    s_waitcnt lgkmcnt(14)
    v_mfma_f32_16x16x32_bf16 v[56:59], a[72:75], v[152:155], v[56:59]
    ds_read_b64_tr_b16 v[184:185], v242 offset:4096
    v_mfma_f32_16x16x32_bf16 v[72:75], a[76:79], v[152:155], v[72:75]
    ds_read_b64_tr_b16 v[186:187], v242 offset:5120
    s_waitcnt lgkmcnt(14)
    v_mfma_f32_16x16x32_bf16 v[60:63], a[72:75], v[156:159], v[60:63]
    ds_read_b64_tr_b16 v[188:189], v243 offset:4096
    v_mfma_f32_16x16x32_bf16 v[76:79], a[76:79], v[156:159], v[76:79]
    ds_read_b64_tr_b16 v[190:191], v243 offset:5120
    s_waitcnt lgkmcnt(14)
    v_mfma_f32_16x16x32_bf16 v[224:227], v[160:163], v[160:163], v[224:227]
    s_mov_b32 s29, 12288
    buffer_load_dwordx4 a[48:51], v8, s[8:11], s29 offen offset:0 sc1
    v_mfma_f32_16x16x32_bf16 v[228:231], v[232:235], v[160:163], v[228:231]
    buffer_load_dwordx4 a[52:55], v8, s[8:11], s29 offen offset:1024 sc1
    v_mfma_f32_16x16x32_bf16 v[48:51], a[80:83], v[160:163], v[48:51]
    ds_read_b64_tr_b16 v[96:97], v240 offset:8192
    v_mfma_f32_16x16x32_bf16 v[64:67], a[84:87], v[160:163], v[64:67]
    ds_read_b64_tr_b16 v[98:99], v240 offset:9216
    s_waitcnt lgkmcnt(14)
    v_mfma_f32_16x16x32_bf16 v[52:55], a[80:83], v[164:167], v[52:55]
    ds_read_b64_tr_b16 v[100:101], v241 offset:8192
    v_mfma_f32_16x16x32_bf16 v[68:71], a[84:87], v[164:167], v[68:71]
    ds_read_b64_tr_b16 v[102:103], v241 offset:9216
    s_waitcnt lgkmcnt(14)
    v_mfma_f32_16x16x32_bf16 v[56:59], a[80:83], v[168:171], v[56:59]
    ds_read_b64_tr_b16 v[104:105], v242 offset:8192
    v_mfma_f32_16x16x32_bf16 v[72:75], a[84:87], v[168:171], v[72:75]
    ds_read_b64_tr_b16 v[106:107], v242 offset:9216
    s_waitcnt lgkmcnt(14)
    v_mfma_f32_16x16x32_bf16 v[60:63], a[80:83], v[172:175], v[60:63]
    ds_read_b64_tr_b16 v[108:109], v243 offset:8192
    v_mfma_f32_16x16x32_bf16 v[76:79], a[84:87], v[172:175], v[76:79]
    ds_read_b64_tr_b16 v[110:111], v243 offset:9216
    s_waitcnt lgkmcnt(14)
    v_mfma_f32_16x16x32_bf16 v[224:227], v[176:179], v[176:179], v[224:227]
    buffer_load_dwordx4 a[56:59], v8, s[8:11], s29 offen offset:2048 sc1
    v_mfma_f32_16x16x32_bf16 v[228:231], v[232:235], v[176:179], v[228:231]
    buffer_load_dwordx4 a[60:63], v8, s[8:11], s29 offen offset:3072 sc1
    v_mfma_f32_16x16x32_bf16 v[48:51], a[88:91], v[176:179], v[48:51]
    ds_read_b64_tr_b16 v[112:113], v240 offset:12288
    v_mfma_f32_16x16x32_bf16 v[64:67], a[92:95], v[176:179], v[64:67]
    ds_read_b64_tr_b16 v[114:115], v240 offset:13312
    s_waitcnt lgkmcnt(14)
    v_mfma_f32_16x16x32_bf16 v[52:55], a[88:91], v[180:183], v[52:55]
    ds_read_b64_tr_b16 v[116:117], v241 offset:12288
    v_mfma_f32_16x16x32_bf16 v[68:71], a[92:95], v[180:183], v[68:71]
    ds_read_b64_tr_b16 v[118:119], v241 offset:13312
    s_waitcnt lgkmcnt(14)
    v_mfma_f32_16x16x32_bf16 v[56:59], a[88:91], v[184:187], v[56:59]
    ds_read_b64_tr_b16 v[120:121], v242 offset:12288
    v_mfma_f32_16x16x32_bf16 v[72:75], a[92:95], v[184:187], v[72:75]
    ds_read_b64_tr_b16 v[122:123], v242 offset:13312
    s_waitcnt lgkmcnt(14)
    v_mfma_f32_16x16x32_bf16 v[60:63], a[88:91], v[188:191], v[60:63]
    ds_read_b64_tr_b16 v[124:125], v243 offset:12288
    v_mfma_f32_16x16x32_bf16 v[76:79], a[92:95], v[188:191], v[76:79]
    ds_read_b64_tr_b16 v[126:127], v243 offset:13312
    s_waitcnt lgkmcnt(14)
    v_mfma_f32_16x16x32_bf16 v[224:227], v[96:99], v[96:99], v[224:227]
    s_mov_b32 s29, 16384
    buffer_load_dwordx4 a[64:67], v8, s[8:11], s29 offen offset:0 sc1
    v_mfma_f32_16x16x32_bf16 v[228:231], v[232:235], v[96:99], v[228:231]
    buffer_load_dwordx4 a[68:71], v8, s[8:11], s29 offen offset:1024 sc1
    v_mfma_f32_16x16x32_bf16 v[48:51], a[96:99], v[96:99], v[48:51]
    ds_read_b64_tr_b16 v[128:129], v240 offset:16384
    v_mfma_f32_16x16x32_bf16 v[64:67], a[100:103], v[96:99], v[64:67]
    ds_read_b64_tr_b16 v[130:131], v240 offset:17408
    s_waitcnt lgkmcnt(14)
    v_mfma_f32_16x16x32_bf16 v[52:55], a[96:99], v[100:103], v[52:55]
    ds_read_b64_tr_b16 v[132:133], v241 offset:16384
    v_mfma_f32_16x16x32_bf16 v[68:71], a[100:103], v[100:103], v[68:71]
    ds_read_b64_tr_b16 v[134:135], v241 offset:17408
    s_waitcnt lgkmcnt(14)
    v_mfma_f32_16x16x32_bf16 v[56:59], a[96:99], v[104:107], v[56:59]
    ds_read_b64_tr_b16 v[136:137], v242 offset:16384
    v_mfma_f32_16x16x32_bf16 v[72:75], a[100:103], v[104:107], v[72:75]
    ds_read_b64_tr_b16 v[138:139], v242 offset:17408
    s_waitcnt lgkmcnt(14)
    v_mfma_f32_16x16x32_bf16 v[60:63], a[96:99], v[108:111], v[60:63]
    ds_read_b64_tr_b16 v[140:141], v243 offset:16384
    v_mfma_f32_16x16x32_bf16 v[76:79], a[100:103], v[108:111], v[76:79]
    ds_read_b64_tr_b16 v[142:143], v243 offset:17408
    s_waitcnt lgkmcnt(14)
    v_mfma_f32_16x16x32_bf16 v[224:227], v[112:115], v[112:115], v[224:227]
    buffer_load_dwordx4 a[72:75], v8, s[8:11], s29 offen offset:2048 sc1
    v_mfma_f32_16x16x32_bf16 v[228:231], v[232:235], v[112:115], v[228:231]
    buffer_load_dwordx4 a[76:79], v8, s[8:11], s29 offen offset:3072 sc1
    v_mfma_f32_16x16x32_bf16 v[48:51], a[104:107], v[112:115], v[48:51]
    ds_read_b64_tr_b16 v[144:145], v240 offset:20480
    v_mfma_f32_16x16x32_bf16 v[64:67], a[108:111], v[112:115], v[64:67]
    ds_read_b64_tr_b16 v[146:147], v240 offset:21504
    s_waitcnt lgkmcnt(14)
    v_mfma_f32_16x16x32_bf16 v[52:55], a[104:107], v[116:119], v[52:55]
    ds_read_b64_tr_b16 v[148:149], v241 offset:20480
    v_mfma_f32_16x16x32_bf16 v[68:71], a[108:111], v[116:119], v[68:71]
    ds_read_b64_tr_b16 v[150:151], v241 offset:21504
    s_waitcnt lgkmcnt(14)
    v_mfma_f32_16x16x32_bf16 v[56:59], a[104:107], v[120:123], v[56:59]
    ds_read_b64_tr_b16 v[152:153], v242 offset:20480
    v_mfma_f32_16x16x32_bf16 v[72:75], a[108:111], v[120:123], v[72:75]
    ds_read_b64_tr_b16 v[154:155], v242 offset:21504
    s_waitcnt lgkmcnt(14)
    v_mfma_f32_16x16x32_bf16 v[60:63], a[104:107], v[124:127], v[60:63]
    ds_read_b64_tr_b16 v[156:157], v243 offset:20480
    v_mfma_f32_16x16x32_bf16 v[76:79], a[108:111], v[124:127], v[76:79]
    ds_read_b64_tr_b16 v[158:159], v243 offset:21504
    s_waitcnt lgkmcnt(14)
    v_mfma_f32_16x16x32_bf16 v[224:227], v[128:131], v[128:131], v[224:227]
    s_mov_b32 s29, 20480
    buffer_load_dwordx4 a[80:83], v8, s[8:11], s29 offen offset:0 sc1
    v_mfma_f32_16x16x32_bf16 v[228:231], v[232:235], v[128:131], v[228:231]
    buffer_load_dwordx4 a[84:87], v8, s[8:11], s29 offen offset:1024 sc1
    v_mfma_f32_16x16x32_bf16 v[48:51], a[112:115], v[128:131], v[48:51]
    ds_read_b64_tr_b16 v[160:161], v240 offset:24576
    v_mfma_f32_16x16x32_bf16 v[64:67], a[116:119], v[128:131], v[64:67]
    ds_read_b64_tr_b16 v[162:163], v240 offset:25600
    s_waitcnt lgkmcnt(14)
    v_mfma_f32_16x16x32_bf16 v[52:55], a[112:115], v[132:135], v[52:55]
    ds_read_b64_tr_b16 v[164:165], v241 offset:24576
    v_mfma_f32_16x16x32_bf16 v[68:71], a[116:119], v[132:135], v[68:71]
    ds_read_b64_tr_b16 v[166:167], v241 offset:25600
    s_waitcnt lgkmcnt(14)
    v_mfma_f32_16x16x32_bf16 v[56:59], a[112:115], v[136:139], v[56:59]
    ds_read_b64_tr_b16 v[168:169], v242 offset:24576
    v_mfma_f32_16x16x32_bf16 v[72:75], a[116:119], v[136:139], v[72:75]
    ds_read_b64_tr_b16 v[170:171], v242 offset:25600
    s_waitcnt lgkmcnt(14)
    v_mfma_f32_16x16x32_bf16 v[60:63], a[112:115], v[140:143], v[60:63]
    ds_read_b64_tr_b16 v[172:173], v243 offset:24576
    v_mfma_f32_16x16x32_bf16 v[76:79], a[116:119], v[140:143], v[76:79]
    ds_read_b64_tr_b16 v[174:175], v243 offset:25600
    s_waitcnt lgkmcnt(14)
    v_mfma_f32_16x16x32_bf16 v[224:227], v[144:147], v[144:147], v[224:227]
    buffer_load_dwordx4 a[88:91], v8, s[8:11], s29 offen offset:2048 sc1
    v_mfma_f32_16x16x32_bf16 v[228:231], v[232:235], v[144:147], v[228:231]
    buffer_load_dwordx4 a[92:95], v8, s[8:11], s29 offen offset:3072 sc1
    v_mfma_f32_16x16x32_bf16 v[48:51], a[120:123], v[144:147], v[48:51]
    ds_read_b64_tr_b16 v[176:177], v240 offset:28672
    v_mfma_f32_16x16x32_bf16 v[64:67], a[124:127], v[144:147], v[64:67]
    ds_read_b64_tr_b16 v[178:179], v240 offset:29696
    s_waitcnt lgkmcnt(14)
    v_mfma_f32_16x16x32_bf16 v[52:55], a[120:123], v[148:151], v[52:55]
    ds_read_b64_tr_b16 v[180:181], v241 offset:28672
    v_mfma_f32_16x16x32_bf16 v[68:71], a[124:127], v[148:151], v[68:71]
    ds_read_b64_tr_b16 v[182:183], v241 offset:29696
    s_waitcnt lgkmcnt(14)
    v_mfma_f32_16x16x32_bf16 v[56:59], a[120:123], v[152:155], v[56:59]
    ds_read_b64_tr_b16 v[184:185], v242 offset:28672
    v_mfma_f32_16x16x32_bf16 v[72:75], a[124:127], v[152:155], v[72:75]
    ds_read_b64_tr_b16 v[186:187], v242 offset:29696
    s_waitcnt lgkmcnt(14)
    v_mfma_f32_16x16x32_bf16 v[60:63], a[120:123], v[156:159], v[60:63]
    ds_read_b64_tr_b16 v[188:189], v243 offset:28672
    v_mfma_f32_16x16x32_bf16 v[76:79], a[124:127], v[156:159], v[76:79]
    ds_read_b64_tr_b16 v[190:191], v243 offset:29696
    s_waitcnt lgkmcnt(14)
    v_mfma_f32_16x16x32_bf16 v[224:227], v[160:163], v[160:163], v[224:227]
    s_mov_b32 s29, 24576
    buffer_load_dwordx4 a[96:99], v8, s[8:11], s29 offen offset:0 sc1
    v_mfma_f32_16x16x32_bf16 v[228:231], v[232:235], v[160:163], v[228:231]
    buffer_load_dwordx4 a[100:103], v8, s[8:11], s29 offen offset:1024 sc1
    v_mfma_f32_16x16x32_bf16 v[48:51], a[128:131], v[160:163], v[48:51]
    ds_read_b64_tr_b16 v[96:97], v240 offset:32768
    v_mfma_f32_16x16x32_bf16 v[64:67], a[132:135], v[160:163], v[64:67]
    ds_read_b64_tr_b16 v[98:99], v240 offset:33792
    s_waitcnt lgkmcnt(14)
    v_mfma_f32_16x16x32_bf16 v[52:55], a[128:131], v[164:167], v[52:55]
    ds_read_b64_tr_b16 v[100:101], v241 offset:32768
    v_mfma_f32_16x16x32_bf16 v[68:71], a[132:135], v[164:167], v[68:71]
    ds_read_b64_tr_b16 v[102:103], v241 offset:33792
    s_waitcnt lgkmcnt(14)
    v_mfma_f32_16x16x32_bf16 v[56:59], a[128:131], v[168:171], v[56:59]
    ds_read_b64_tr_b16 v[104:105], v242 offset:32768
    v_mfma_f32_16x16x32_bf16 v[72:75], a[132:135], v[168:171], v[72:75]
    ds_read_b64_tr_b16 v[106:107], v242 offset:33792
    s_waitcnt lgkmcnt(14)
    v_mfma_f32_16x16x32_bf16 v[60:63], a[128:131], v[172:175], v[60:63]
    ds_read_b64_tr_b16 v[108:109], v243 offset:32768
    v_mfma_f32_16x16x32_bf16 v[76:79], a[132:135], v[172:175], v[76:79]
    ds_read_b64_tr_b16 v[110:111], v243 offset:33792
    s_waitcnt lgkmcnt(14)
    v_mfma_f32_16x16x32_bf16 v[224:227], v[176:179], v[176:179], v[224:227]
    buffer_load_dwordx4 a[104:107], v8, s[8:11], s29 offen offset:2048 sc1
    v_mfma_f32_16x16x32_bf16 v[228:231], v[232:235], v[176:179], v[228:231]
    buffer_load_dwordx4 a[108:111], v8, s[8:11], s29 offen offset:3072 sc1
    v_mfma_f32_16x16x32_bf16 v[48:51], a[136:139], v[176:179], v[48:51]
    ds_read_b64_tr_b16 v[112:113], v240 offset:36864
    v_mfma_f32_16x16x32_bf16 v[64:67], a[140:143], v[176:179], v[64:67]
    ds_read_b64_tr_b16 v[114:115], v240 offset:37888
    s_waitcnt lgkmcnt(14)
    v_mfma_f32_16x16x32_bf16 v[52:55], a[136:139], v[180:183], v[52:55]
    ds_read_b64_tr_b16 v[116:117], v241 offset:36864
    v_mfma_f32_16x16x32_bf16 v[68:71], a[140:143], v[180:183], v[68:71]
    ds_read_b64_tr_b16 v[118:119], v241 offset:37888
    s_waitcnt lgkmcnt(14)
    v_mfma_f32_16x16x32_bf16 v[56:59], a[136:139], v[184:187], v[56:59]
    ds_read_b64_tr_b16 v[120:121], v242 offset:36864
    v_mfma_f32_16x16x32_bf16 v[72:75], a[140:143], v[184:187], v[72:75]
    ds_read_b64_tr_b16 v[122:123], v242 offset:37888
    s_waitcnt lgkmcnt(14)
    v_mfma_f32_16x16x32_bf16 v[60:63], a[136:139], v[188:191], v[60:63]
    ds_read_b64_tr_b16 v[124:125], v243 offset:36864
    v_mfma_f32_16x16x32_bf16 v[76:79], a[140:143], v[188:191], v[76:79]
    ds_read_b64_tr_b16 v[126:127], v243 offset:37888
    s_waitcnt lgkmcnt(14)
    v_mfma_f32_16x16x32_bf16 v[224:227], v[96:99], v[96:99], v[224:227]
    s_mov_b32 s29, 28672
    buffer_load_dwordx4 a[112:115], v8, s[8:11], s29 offen offset:0 sc1
    v_mfma_f32_16x16x32_bf16 v[228:231], v[232:235], v[96:99], v[228:231]
    buffer_load_dwordx4 a[116:119], v8, s[8:11], s29 offen offset:1024 sc1
    v_mfma_f32_16x16x32_bf16 v[48:51], a[144:147], v[96:99], v[48:51]
    v_mfma_f32_16x16x32_bf16 v[64:67], a[148:151], v[96:99], v[64:67]
    s_waitcnt lgkmcnt(12)
    v_mfma_f32_16x16x32_bf16 v[52:55], a[144:147], v[100:103], v[52:55]
    v_mfma_f32_16x16x32_bf16 v[68:71], a[148:151], v[100:103], v[68:71]
    s_waitcnt lgkmcnt(10)
    v_mfma_f32_16x16x32_bf16 v[56:59], a[144:147], v[104:107], v[56:59]
    v_mfma_f32_16x16x32_bf16 v[72:75], a[148:151], v[104:107], v[72:75]
    s_waitcnt lgkmcnt(8)
    v_mfma_f32_16x16x32_bf16 v[60:63], a[144:147], v[108:111], v[60:63]
    v_mfma_f32_16x16x32_bf16 v[76:79], a[148:151], v[108:111], v[76:79]
    s_waitcnt lgkmcnt(6)
    v_mfma_f32_16x16x32_bf16 v[224:227], v[112:115], v[112:115], v[224:227]
    buffer_load_dwordx4 a[120:123], v8, s[8:11], s29 offen offset:2048 sc1
    v_mfma_f32_16x16x32_bf16 v[228:231], v[232:235], v[112:115], v[228:231]
    buffer_load_dwordx4 a[124:127], v8, s[8:11], s29 offen offset:3072 sc1
    v_mfma_f32_16x16x32_bf16 v[48:51], a[152:155], v[112:115], v[48:51]
    v_mfma_f32_16x16x32_bf16 v[64:67], a[156:159], v[112:115], v[64:67]
    s_waitcnt lgkmcnt(4)
    v_mfma_f32_16x16x32_bf16 v[52:55], a[152:155], v[116:119], v[52:55]
    v_mfma_f32_16x16x32_bf16 v[68:71], a[156:159], v[116:119], v[68:71]
    s_waitcnt lgkmcnt(2)
    v_mfma_f32_16x16x32_bf16 v[56:59], a[152:155], v[120:123], v[56:59]
    v_mfma_f32_16x16x32_bf16 v[72:75], a[156:159], v[120:123], v[72:75]
    s_waitcnt lgkmcnt(0)
    v_mfma_f32_16x16x32_bf16 v[60:63], a[152:155], v[124:127], v[60:63]
    v_mfma_f32_16x16x32_bf16 v[76:79], a[156:159], v[124:127], v[76:79]
    v_mfma_f32_16x16x32_bf16 v[80:83], a[216:219], v[128:131], 0
    v_cndmask_b32 v13, v224, v225, s[84:85]
    v_mul_f32 v12, 986500301, v228
    v_mfma_f32_16x16x32_bf16 v[84:87], a[216:219], v[132:135], 0
    v_cndmask_b32 v13, v13, v226, s[86:87]
    v_cndmask_b32 v13, v13, v227, s[88:89]
    s_mov_b32 s29, 32768
    buffer_load_dwordx4 a[128:131], v8, s[8:11], s29 offen offset:0 sc1
    v_mfma_f32_16x16x32_bf16 v[88:91], a[216:219], v[136:139], 0
    v_mul_f32 v13, 986500301, v13
    v_fma_f32 v13, -v12, v12, v13
    v_mfma_f32_16x16x32_bf16 v[92:95], a[216:219], v[140:143], 0
    v_max_f32 v13, 0, v13
    v_cvt_pk_bf16_f32 v13, v13, v12
    buffer_load_dwordx4 a[132:135], v8, s[8:11], s29 offen offset:1024 sc1
    v_mfma_f32_16x16x32_bf16 v[80:83], a[220:223], v[144:147], v[80:83]
    v_and_b32 v12, 0xffff0000, v13
    v_lshlrev_b32 v13, 16, v13
    v_mfma_f32_16x16x32_bf16 v[84:87], a[220:223], v[148:151], v[84:87]
    v_add_f32 v13, 925353388, v13
    v_cvt_pk_bf16_f32 v13, v13, v13
    buffer_load_dwordx4 a[136:139], v8, s[8:11], s29 offen offset:2048 sc1
    v_mfma_f32_16x16x32_bf16 v[88:91], a[220:223], v[152:155], v[88:91]
    v_lshlrev_b32 v13, 16, v13
    v_sqrt_f32 v13, v13
    v_mfma_f32_16x16x32_bf16 v[92:95], a[220:223], v[156:159], v[92:95]
    v_cvt_pk_bf16_f32 v13, v13, v13
    v_lshlrev_b32 v13, 16, v13
    buffer_load_dwordx4 a[140:143], v8, s[8:11], s29 offen offset:3072 sc1
    v_mfma_f32_16x16x32_bf16 v[80:83], a[224:227], v[160:163], v[80:83]
    v_rcp_f32 v13, v13
    s_nop 0
    v_mul_f32 v13, 3216550459, v13
    v_mfma_f32_16x16x32_bf16 v[84:87], a[224:227], v[164:167], v[84:87]
    s_mov_b64 exec, s[90:91]
    ds_write_b64 v9, v[12:13]
    s_mov_b64 exec, -1
    s_waitcnt lgkmcnt(0)
    s_barrier
    s_mov_b32 s29, 36864
    buffer_load_dwordx4 a[144:147], v8, s[8:11], s29 offen offset:0 sc1
    v_mfma_f32_16x16x32_bf16 v[88:91], a[224:227], v[168:171], v[88:91]
    v_xor_b32 v13, 0, v9
    ds_read_b64 v[16:17], v13
    v_xor_b32 v13, 128, v9
    ds_read_b64 v[18:19], v13
    v_mfma_f32_16x16x32_bf16 v[92:95], a[224:227], v[172:175], v[92:95]
    v_xor_b32 v13, 256, v9
    ds_read_b64 v[20:21], v13
    v_xor_b32 v13, 384, v9
    ds_read_b64 v[22:23], v13
    buffer_load_dwordx4 a[148:151], v8, s[8:11], s29 offen offset:1024 sc1
    v_mfma_f32_16x16x32_bf16 v[80:83], a[228:231], v[176:179], v[80:83]
    v_mfma_f32_16x16x32_bf16 v[84:87], a[228:231], v[180:183], v[84:87]
    buffer_load_dwordx4 a[152:155], v8, s[8:11], s29 offen offset:2048 sc1
    v_mfma_f32_16x16x32_bf16 v[88:91], a[228:231], v[184:187], v[88:91]
    v_mfma_f32_16x16x32_bf16 v[92:95], a[228:231], v[188:191], v[92:95]
    buffer_load_dwordx4 a[156:159], v8, s[8:11], s29 offen offset:3072 sc1
    s_waitcnt lgkmcnt(2)
    v_add_f32 v12, v16, v18
    s_waitcnt lgkmcnt(0)
    v_add_f32 v13, v20, v22
    s_cmp_lt_u32 s71, 3
    v_add_f32 v12, v12, v13
    s_cselect_b64 s[30:31], -1, 0
    v_cmp_u_f32 vcc, v12, v12
    s_nop 0
    s_and_b64 vcc, vcc, s[30:31]
    s_cbranch_vccnz LF_xredo
    v_mfma_f32_16x16x32_bf16 v[80:83], a[232:235], v[96:99], v[80:83]
    ds_read_b64_tr_b16 v[128:129], v236 offset:0
    ds_read_b64_tr_b16 v[130:131], v236 offset:1024
    v_mfma_f32_16x16x32_bf16 v[84:87], a[232:235], v[100:103], v[84:87]
    ds_read_b64_tr_b16 v[132:133], v237 offset:0
    ds_read_b64_tr_b16 v[134:135], v237 offset:1024
    s_mov_b32 s29, 40960
    buffer_load_dwordx4 a[216:219], v8, s[8:11], s29 offen offset:0 sc1
    v_mfma_f32_16x16x32_bf16 v[88:91], a[232:235], v[104:107], v[88:91]
    ds_read_b64_tr_b16 v[136:137], v238 offset:0
    ds_read_b64_tr_b16 v[138:139], v238 offset:1024
    v_mfma_f32_16x16x32_bf16 v[92:95], a[232:235], v[108:111], v[92:95]
    ds_read_b64_tr_b16 v[140:141], v239 offset:0
    ds_read_b64_tr_b16 v[142:143], v239 offset:1024
    buffer_load_dwordx4 a[220:223], v8, s[8:11], s29 offen offset:1024 sc1
    v_mfma_f32_16x16x32_bf16 v[80:83], a[236:239], v[112:115], v[80:83]
    ds_read_b64_tr_b16 v[144:145], v236 offset:4096
    ds_read_b64_tr_b16 v[146:147], v236 offset:5120
    v_mfma_f32_16x16x32_bf16 v[84:87], a[236:239], v[116:119], v[84:87]
    ds_read_b64_tr_b16 v[148:149], v237 offset:4096
    ds_read_b64_tr_b16 v[150:151], v237 offset:5120
    buffer_load_dwordx4 a[224:227], v8, s[8:11], s29 offen offset:2048 sc1
    v_mfma_f32_16x16x32_bf16 v[88:91], a[236:239], v[120:123], v[88:91]
    ds_read_b64_tr_b16 v[152:153], v238 offset:4096
    ds_read_b64_tr_b16 v[154:155], v238 offset:5120
    v_mfma_f32_16x16x32_bf16 v[92:95], a[236:239], v[124:127], v[92:95]
    ds_read_b64_tr_b16 v[156:157], v239 offset:4096
    ds_read_b64_tr_b16 v[158:159], v239 offset:5120
    buffer_load_dwordx4 a[228:231], v8, s[8:11], s29 offen offset:3072 sc1
    v_pk_fma_f32 v[48:49], v[24:25], v[16:17], v[48:49] op_sel_hi:[1,0,1] neg_lo:[1,0,0] neg_hi:[1,0,0]
    v_pk_fma_f32 v[50:51], v[26:27], v[16:17], v[50:51] op_sel_hi:[1,0,1] neg_lo:[1,0,0] neg_hi:[1,0,0]
    v_pk_fma_f32 v[52:53], v[24:25], v[18:19], v[52:53] op_sel_hi:[1,0,1] neg_lo:[1,0,0] neg_hi:[1,0,0]
    v_pk_fma_f32 v[54:55], v[26:27], v[18:19], v[54:55] op_sel_hi:[1,0,1] neg_lo:[1,0,0] neg_hi:[1,0,0]
    v_pk_fma_f32 v[56:57], v[24:25], v[20:21], v[56:57] op_sel_hi:[1,0,1] neg_lo:[1,0,0] neg_hi:[1,0,0]
    v_pk_fma_f32 v[58:59], v[26:27], v[20:21], v[58:59] op_sel_hi:[1,0,1] neg_lo:[1,0,0] neg_hi:[1,0,0]
    v_pk_fma_f32 v[60:61], v[24:25], v[22:23], v[60:61] op_sel_hi:[1,0,1] neg_lo:[1,0,0] neg_hi:[1,0,0]
    v_pk_fma_f32 v[62:63], v[26:27], v[22:23], v[62:63] op_sel_hi:[1,0,1] neg_lo:[1,0,0] neg_hi:[1,0,0]
    v_pk_fma_f32 v[48:49], v[48:49], v[16:17], v[28:29] op_sel:[0,1,0] op_sel_hi:[1,1,1]
    v_pk_fma_f32 v[50:51], v[50:51], v[16:17], v[30:31] op_sel:[0,1,0] op_sel_hi:[1,1,1]
    v_pk_fma_f32 v[52:53], v[52:53], v[18:19], v[28:29] op_sel:[0,1,0] op_sel_hi:[1,1,1]
    v_pk_fma_f32 v[54:55], v[54:55], v[18:19], v[30:31] op_sel:[0,1,0] op_sel_hi:[1,1,1]
    v_pk_fma_f32 v[56:57], v[56:57], v[20:21], v[28:29] op_sel:[0,1,0] op_sel_hi:[1,1,1]
    v_pk_fma_f32 v[58:59], v[58:59], v[20:21], v[30:31] op_sel:[0,1,0] op_sel_hi:[1,1,1]
    v_pk_fma_f32 v[60:61], v[60:61], v[22:23], v[28:29] op_sel:[0,1,0] op_sel_hi:[1,1,1]
    v_pk_fma_f32 v[62:63], v[62:63], v[22:23], v[30:31] op_sel:[0,1,0] op_sel_hi:[1,1,1]
    v_exp_f32 v192, v48
    v_exp_f32 v193, v49
    v_exp_f32 v194, v50
    v_exp_f32 v195, v51
    v_exp_f32 v196, v52
    v_exp_f32 v197, v53
    v_exp_f32 v198, v54
    v_exp_f32 v199, v55
    v_exp_f32 v200, v56
    v_exp_f32 v201, v57
    v_exp_f32 v202, v58
    v_exp_f32 v203, v59
    v_exp_f32 v204, v60
    v_exp_f32 v205, v61
    v_exp_f32 v206, v62
    v_exp_f32 v207, v63
    v_pk_add_f32 v[192:193], v[192:193], 1.0 op_sel_hi:[1,0]
    v_pk_add_f32 v[194:195], v[194:195], 1.0 op_sel_hi:[1,0]
    v_pk_add_f32 v[196:197], v[196:197], 1.0 op_sel_hi:[1,0]
    v_pk_add_f32 v[198:199], v[198:199], 1.0 op_sel_hi:[1,0]
    v_pk_add_f32 v[200:201], v[200:201], 1.0 op_sel_hi:[1,0]
    v_pk_add_f32 v[202:203], v[202:203], 1.0 op_sel_hi:[1,0]
    v_pk_add_f32 v[204:205], v[204:205], 1.0 op_sel_hi:[1,0]
    v_pk_add_f32 v[206:207], v[206:207], 1.0 op_sel_hi:[1,0]
    v_rcp_f32 v192, v192
    v_rcp_f32 v193, v193
    v_rcp_f32 v194, v194
    v_rcp_f32 v195, v195
    v_rcp_f32 v196, v196
    v_rcp_f32 v197, v197
    v_rcp_f32 v198, v198
    v_rcp_f32 v199, v199
    s_mov_b32 s29, 45056
    buffer_load_dwordx4 a[232:235], v8, s[8:11], s29 offen offset:0 sc1
    v_rcp_f32 v200, v200
    v_rcp_f32 v201, v201
    v_rcp_f32 v202, v202
    v_rcp_f32 v203, v203
    v_rcp_f32 v204, v204
    v_rcp_f32 v205, v205
    v_rcp_f32 v206, v206
    v_rcp_f32 v207, v207
    v_pk_mul_f32 v[48:49], v[48:49], v[192:193]
    v_pk_mul_f32 v[50:51], v[50:51], v[194:195]
    v_pk_mul_f32 v[52:53], v[52:53], v[196:197]
    v_pk_mul_f32 v[54:55], v[54:55], v[198:199]
    v_pk_mul_f32 v[56:57], v[56:57], v[200:201]
    v_pk_mul_f32 v[58:59], v[58:59], v[202:203]
    v_pk_mul_f32 v[60:61], v[60:61], v[204:205]
    v_pk_mul_f32 v[62:63], v[62:63], v[206:207]
    v_cvt_pk_bf16_f32 v208, v48, v49
    v_cvt_pk_bf16_f32 v209, v50, v51
    v_cvt_pk_bf16_f32 v212, v52, v53
    v_cvt_pk_bf16_f32 v213, v54, v55
    v_cvt_pk_bf16_f32 v216, v56, v57
    v_cvt_pk_bf16_f32 v217, v58, v59
    v_cvt_pk_bf16_f32 v220, v60, v61
    v_cvt_pk_bf16_f32 v221, v62, v63
    v_pk_fma_f32 v[64:65], v[32:33], v[16:17], v[64:65] op_sel_hi:[1,0,1] neg_lo:[1,0,0] neg_hi:[1,0,0]
    v_pk_fma_f32 v[66:67], v[34:35], v[16:17], v[66:67] op_sel_hi:[1,0,1] neg_lo:[1,0,0] neg_hi:[1,0,0]
    v_pk_fma_f32 v[68:69], v[32:33], v[18:19], v[68:69] op_sel_hi:[1,0,1] neg_lo:[1,0,0] neg_hi:[1,0,0]
    v_pk_fma_f32 v[70:71], v[34:35], v[18:19], v[70:71] op_sel_hi:[1,0,1] neg_lo:[1,0,0] neg_hi:[1,0,0]
    v_pk_fma_f32 v[72:73], v[32:33], v[20:21], v[72:73] op_sel_hi:[1,0,1] neg_lo:[1,0,0] neg_hi:[1,0,0]
    v_pk_fma_f32 v[74:75], v[34:35], v[20:21], v[74:75] op_sel_hi:[1,0,1] neg_lo:[1,0,0] neg_hi:[1,0,0]
    v_pk_fma_f32 v[76:77], v[32:33], v[22:23], v[76:77] op_sel_hi:[1,0,1] neg_lo:[1,0,0] neg_hi:[1,0,0]
    v_pk_fma_f32 v[78:79], v[34:35], v[22:23], v[78:79] op_sel_hi:[1,0,1] neg_lo:[1,0,0] neg_hi:[1,0,0]
    v_pk_fma_f32 v[64:65], v[64:65], v[16:17], v[36:37] op_sel:[0,1,0] op_sel_hi:[1,1,1]
    v_pk_fma_f32 v[66:67], v[66:67], v[16:17], v[38:39] op_sel:[0,1,0] op_sel_hi:[1,1,1]
    v_pk_fma_f32 v[68:69], v[68:69], v[18:19], v[36:37] op_sel:[0,1,0] op_sel_hi:[1,1,1]
    v_pk_fma_f32 v[70:71], v[70:71], v[18:19], v[38:39] op_sel:[0,1,0] op_sel_hi:[1,1,1]
    v_pk_fma_f32 v[72:73], v[72:73], v[20:21], v[36:37] op_sel:[0,1,0] op_sel_hi:[1,1,1]
    v_pk_fma_f32 v[74:75], v[74:75], v[20:21], v[38:39] op_sel:[0,1,0] op_sel_hi:[1,1,1]
    v_pk_fma_f32 v[76:77], v[76:77], v[22:23], v[36:37] op_sel:[0,1,0] op_sel_hi:[1,1,1]
    v_pk_fma_f32 v[78:79], v[78:79], v[22:23], v[38:39] op_sel:[0,1,0] op_sel_hi:[1,1,1]
    v_exp_f32 v192, v64
    v_exp_f32 v193, v65
    v_exp_f32 v194, v66
    v_exp_f32 v195, v67
    v_exp_f32 v196, v68
    v_exp_f32 v197, v69
    v_exp_f32 v198, v70
    v_exp_f32 v199, v71
    buffer_load_dwordx4 a[236:239], v8, s[8:11], s29 offen offset:1024 sc1
    v_exp_f32 v200, v72
    v_exp_f32 v201, v73
    v_exp_f32 v202, v74
    v_exp_f32 v203, v75
    v_exp_f32 v204, v76
    v_exp_f32 v205, v77
    v_exp_f32 v206, v78
    v_exp_f32 v207, v79
    v_pk_add_f32 v[192:193], v[192:193], 1.0 op_sel_hi:[1,0]
    v_pk_add_f32 v[194:195], v[194:195], 1.0 op_sel_hi:[1,0]
    v_pk_add_f32 v[196:197], v[196:197], 1.0 op_sel_hi:[1,0]
    v_pk_add_f32 v[198:199], v[198:199], 1.0 op_sel_hi:[1,0]
    v_pk_add_f32 v[200:201], v[200:201], 1.0 op_sel_hi:[1,0]
    v_pk_add_f32 v[202:203], v[202:203], 1.0 op_sel_hi:[1,0]
    v_pk_add_f32 v[204:205], v[204:205], 1.0 op_sel_hi:[1,0]
    v_pk_add_f32 v[206:207], v[206:207], 1.0 op_sel_hi:[1,0]
    v_rcp_f32 v192, v192
    v_rcp_f32 v193, v193
    v_rcp_f32 v194, v194
    v_rcp_f32 v195, v195
    v_rcp_f32 v196, v196
    v_rcp_f32 v197, v197
    v_rcp_f32 v198, v198
    v_rcp_f32 v199, v199
    v_rcp_f32 v200, v200
    v_rcp_f32 v201, v201
    v_rcp_f32 v202, v202
    v_rcp_f32 v203, v203
    v_rcp_f32 v204, v204
    v_rcp_f32 v205, v205
    v_rcp_f32 v206, v206
    v_rcp_f32 v207, v207
    v_pk_mul_f32 v[64:65], v[64:65], v[192:193]
    v_pk_mul_f32 v[66:67], v[66:67], v[194:195]
    v_pk_mul_f32 v[68:69], v[68:69], v[196:197]
    v_pk_mul_f32 v[70:71], v[70:71], v[198:199]
    v_pk_mul_f32 v[72:73], v[72:73], v[200:201]
    v_pk_mul_f32 v[74:75], v[74:75], v[202:203]
    v_pk_mul_f32 v[76:77], v[76:77], v[204:205]
    v_pk_mul_f32 v[78:79], v[78:79], v[206:207]
    v_cvt_pk_bf16_f32 v210, v64, v65
    v_cvt_pk_bf16_f32 v211, v66, v67
    v_cvt_pk_bf16_f32 v214, v68, v69
    v_cvt_pk_bf16_f32 v215, v70, v71
    v_cvt_pk_bf16_f32 v218, v72, v73
    v_cvt_pk_bf16_f32 v219, v74, v75
    v_cvt_pk_bf16_f32 v222, v76, v77
    v_cvt_pk_bf16_f32 v223, v78, v79
    v_mov_b32 v14, 1
    v_mov_b32 v15, 2
    buffer_store_dwordx4 v[208:211], v8, s[12:15], s72 offen sc1
    buffer_store_dwordx4 v[212:215], v8, s[12:15], s73 offen sc1
    buffer_store_dwordx4 v[216:219], v8, s[12:15], s74 offen sc1
    buffer_store_dwordx4 v[220:223], v8, s[12:15], s75 offen sc1
    s_mov_b64 exec, 1
    global_store_dword v10, v14, s[68:69] sc1
    s_mov_b64 exec, -1
    s_waitcnt lgkmcnt(14)
    v_mfma_f32_16x16x32_bf16 v[80:83], a[160:163], v[128:131], v[80:83]
    ds_read_b64_tr_b16 v[160:161], v236 offset:8192
    ds_read_b64_tr_b16 v[162:163], v236 offset:9216
    s_waitcnt lgkmcnt(14)
    v_mfma_f32_16x16x32_bf16 v[84:87], a[160:163], v[132:135], v[84:87]
    ds_read_b64_tr_b16 v[164:165], v237 offset:8192
    ds_read_b64_tr_b16 v[166:167], v237 offset:9216
    s_waitcnt lgkmcnt(14)
    v_mfma_f32_16x16x32_bf16 v[88:91], a[160:163], v[136:139], v[88:91]
    ds_read_b64_tr_b16 v[168:169], v238 offset:8192
    ds_read_b64_tr_b16 v[170:171], v238 offset:9216
    s_waitcnt lgkmcnt(14)
    v_mfma_f32_16x16x32_bf16 v[92:95], a[160:163], v[140:143], v[92:95]
    ds_read_b64_tr_b16 v[172:173], v239 offset:8192
    ds_read_b64_tr_b16 v[174:175], v239 offset:9216
    s_waitcnt lgkmcnt(14)
    v_mfma_f32_16x16x32_bf16 v[80:83], a[164:167], v[144:147], v[80:83]
    ds_read_b64_tr_b16 v[176:177], v236 offset:12288
    ds_read_b64_tr_b16 v[178:179], v236 offset:13312
    s_waitcnt lgkmcnt(14)
    v_mfma_f32_16x16x32_bf16 v[84:87], a[164:167], v[148:151], v[84:87]
    ds_read_b64_tr_b16 v[180:181], v237 offset:12288
    ds_read_b64_tr_b16 v[182:183], v237 offset:13312
    buffer_load_dwordx4 a[160:163], v8, s[8:11], s29 offen offset:2048 sc1
    s_waitcnt lgkmcnt(14)
    v_mfma_f32_16x16x32_bf16 v[88:91], a[164:167], v[152:155], v[88:91]
    ds_read_b64_tr_b16 v[184:185], v238 offset:12288
    ds_read_b64_tr_b16 v[186:187], v238 offset:13312
    s_waitcnt lgkmcnt(14)
    v_mfma_f32_16x16x32_bf16 v[92:95], a[164:167], v[156:159], v[92:95]
    ds_read_b64_tr_b16 v[188:189], v239 offset:12288
    ds_read_b64_tr_b16 v[190:191], v239 offset:13312
    s_waitcnt lgkmcnt(14)
    v_mfma_f32_16x16x32_bf16 v[80:83], a[168:171], v[160:163], v[80:83]
    ds_read_b64_tr_b16 v[96:97], v236 offset:16384
    ds_read_b64_tr_b16 v[98:99], v236 offset:17408
    s_waitcnt lgkmcnt(14)
    v_mfma_f32_16x16x32_bf16 v[84:87], a[168:171], v[164:167], v[84:87]
    ds_read_b64_tr_b16 v[100:101], v237 offset:16384
    ds_read_b64_tr_b16 v[102:103], v237 offset:17408
    buffer_load_dwordx4 a[164:167], v8, s[8:11], s29 offen offset:3072 sc1
    s_waitcnt lgkmcnt(14)
    v_mfma_f32_16x16x32_bf16 v[88:91], a[168:171], v[168:171], v[88:91]
    ds_read_b64_tr_b16 v[104:105], v238 offset:16384
    ds_read_b64_tr_b16 v[106:107], v238 offset:17408
    s_waitcnt lgkmcnt(14)
    v_mfma_f32_16x16x32_bf16 v[92:95], a[168:171], v[172:175], v[92:95]
    ds_read_b64_tr_b16 v[108:109], v239 offset:16384
    ds_read_b64_tr_b16 v[110:111], v239 offset:17408
    s_waitcnt lgkmcnt(14)
    v_mfma_f32_16x16x32_bf16 v[80:83], a[172:175], v[176:179], v[80:83]
    ds_read_b64_tr_b16 v[112:113], v236 offset:20480
    ds_read_b64_tr_b16 v[114:115], v236 offset:21504
    s_waitcnt lgkmcnt(14)
    v_mfma_f32_16x16x32_bf16 v[84:87], a[172:175], v[180:183], v[84:87]
    ds_read_b64_tr_b16 v[116:117], v237 offset:20480
    ds_read_b64_tr_b16 v[118:119], v237 offset:21504
    s_mov_b32 s29, 49152
    buffer_load_dwordx4 a[168:171], v8, s[8:11], s29 offen offset:0 sc1
    s_waitcnt lgkmcnt(14)
    v_mfma_f32_16x16x32_bf16 v[88:91], a[172:175], v[184:187], v[88:91]
    ds_read_b64_tr_b16 v[120:121], v238 offset:20480
    ds_read_b64_tr_b16 v[122:123], v238 offset:21504
    s_waitcnt lgkmcnt(14)
    v_mfma_f32_16x16x32_bf16 v[92:95], a[172:175], v[188:191], v[92:95]
    ds_read_b64_tr_b16 v[124:125], v239 offset:20480
    ds_read_b64_tr_b16 v[126:127], v239 offset:21504
    s_waitcnt lgkmcnt(14)
    v_mfma_f32_16x16x32_bf16 v[80:83], a[176:179], v[96:99], v[80:83]
    ds_read_b64_tr_b16 v[128:129], v236 offset:24576
    ds_read_b64_tr_b16 v[130:131], v236 offset:25600
    s_waitcnt lgkmcnt(14)
    v_mfma_f32_16x16x32_bf16 v[84:87], a[176:179], v[100:103], v[84:87]
    ds_read_b64_tr_b16 v[132:133], v237 offset:24576
    ds_read_b64_tr_b16 v[134:135], v237 offset:25600
    buffer_load_dwordx4 a[172:175], v8, s[8:11], s29 offen offset:1024 sc1
    s_waitcnt lgkmcnt(14)
    v_mfma_f32_16x16x32_bf16 v[88:91], a[176:179], v[104:107], v[88:91]
    ds_read_b64_tr_b16 v[136:137], v238 offset:24576
    ds_read_b64_tr_b16 v[138:139], v238 offset:25600
    s_waitcnt lgkmcnt(14)
    v_mfma_f32_16x16x32_bf16 v[92:95], a[176:179], v[108:111], v[92:95]
    ds_read_b64_tr_b16 v[140:141], v239 offset:24576
    ds_read_b64_tr_b16 v[142:143], v239 offset:25600
    s_waitcnt lgkmcnt(14)
    v_mfma_f32_16x16x32_bf16 v[80:83], a[180:183], v[112:115], v[80:83]
    ds_read_b64_tr_b16 v[144:145], v236 offset:28672
    ds_read_b64_tr_b16 v[146:147], v236 offset:29696
    s_waitcnt lgkmcnt(14)
    v_mfma_f32_16x16x32_bf16 v[84:87], a[180:183], v[116:119], v[84:87]
    ds_read_b64_tr_b16 v[148:149], v237 offset:28672
    ds_read_b64_tr_b16 v[150:151], v237 offset:29696
    buffer_load_dwordx4 a[176:179], v8, s[8:11], s29 offen offset:2048 sc1
    s_waitcnt lgkmcnt(14)
    v_mfma_f32_16x16x32_bf16 v[88:91], a[180:183], v[120:123], v[88:91]
    ds_read_b64_tr_b16 v[152:153], v238 offset:28672
    ds_read_b64_tr_b16 v[154:155], v238 offset:29696
    s_waitcnt lgkmcnt(14)
    v_mfma_f32_16x16x32_bf16 v[92:95], a[180:183], v[124:127], v[92:95]
    ds_read_b64_tr_b16 v[156:157], v239 offset:28672
    ds_read_b64_tr_b16 v[158:159], v239 offset:29696
    s_waitcnt lgkmcnt(14)
    v_mfma_f32_16x16x32_bf16 v[80:83], a[184:187], v[128:131], v[80:83]
    ds_read_b64_tr_b16 v[160:161], v236 offset:32768
    ds_read_b64_tr_b16 v[162:163], v236 offset:33792
    s_waitcnt lgkmcnt(14)
    v_mfma_f32_16x16x32_bf16 v[84:87], a[184:187], v[132:135], v[84:87]
    ds_read_b64_tr_b16 v[164:165], v237 offset:32768
    ds_read_b64_tr_b16 v[166:167], v237 offset:33792
    buffer_load_dwordx4 a[180:183], v8, s[8:11], s29 offen offset:3072 sc1
    s_waitcnt lgkmcnt(14)
    v_mfma_f32_16x16x32_bf16 v[88:91], a[184:187], v[136:139], v[88:91]
    ds_read_b64_tr_b16 v[168:169], v238 offset:32768
    ds_read_b64_tr_b16 v[170:171], v238 offset:33792
    s_waitcnt lgkmcnt(14)
    v_mfma_f32_16x16x32_bf16 v[92:95], a[184:187], v[140:143], v[92:95]
    ds_read_b64_tr_b16 v[172:173], v239 offset:32768
    ds_read_b64_tr_b16 v[174:175], v239 offset:33792
    s_waitcnt lgkmcnt(14)
    v_mfma_f32_16x16x32_bf16 v[80:83], a[188:191], v[144:147], v[80:83]
    ds_read_b64_tr_b16 v[176:177], v236 offset:36864
    ds_read_b64_tr_b16 v[178:179], v236 offset:37888
    s_waitcnt lgkmcnt(14)
    v_mfma_f32_16x16x32_bf16 v[84:87], a[188:191], v[148:151], v[84:87]
    ds_read_b64_tr_b16 v[180:181], v237 offset:36864
    ds_read_b64_tr_b16 v[182:183], v237 offset:37888
    s_mov_b32 s29, 53248
    buffer_load_dwordx4 a[184:187], v8, s[8:11], s29 offen offset:0 sc1
    s_waitcnt lgkmcnt(14)
    v_mfma_f32_16x16x32_bf16 v[88:91], a[188:191], v[152:155], v[88:91]
    ds_read_b64_tr_b16 v[184:185], v238 offset:36864
    ds_read_b64_tr_b16 v[186:187], v238 offset:37888
    s_waitcnt lgkmcnt(14)
    v_mfma_f32_16x16x32_bf16 v[92:95], a[188:191], v[156:159], v[92:95]
    ds_read_b64_tr_b16 v[188:189], v239 offset:36864
    ds_read_b64_tr_b16 v[190:191], v239 offset:37888
    s_waitcnt lgkmcnt(14)
    v_mfma_f32_16x16x32_bf16 v[80:83], a[192:195], v[160:163], v[80:83]
    ds_read_b64_tr_b16 v[96:97], v240 offset:0
    ds_read_b64_tr_b16 v[98:99], v240 offset:1024
    s_waitcnt lgkmcnt(14)
    v_mfma_f32_16x16x32_bf16 v[84:87], a[192:195], v[164:167], v[84:87]
    ds_read_b64_tr_b16 v[100:101], v241 offset:0
    ds_read_b64_tr_b16 v[102:103], v241 offset:1024
    buffer_load_dwordx4 a[188:191], v8, s[8:11], s29 offen offset:1024 sc1
    s_waitcnt lgkmcnt(14)
    v_mfma_f32_16x16x32_bf16 v[88:91], a[192:195], v[168:171], v[88:91]
    ds_read_b64_tr_b16 v[104:105], v242 offset:0
    ds_read_b64_tr_b16 v[106:107], v242 offset:1024
    s_waitcnt lgkmcnt(14)
    v_mfma_f32_16x16x32_bf16 v[92:95], a[192:195], v[172:175], v[92:95]
    ds_read_b64_tr_b16 v[108:109], v243 offset:0
    ds_read_b64_tr_b16 v[110:111], v243 offset:1024
    s_waitcnt lgkmcnt(14)
    v_mfma_f32_16x16x32_bf16 v[80:83], a[196:199], v[176:179], v[80:83]
    ds_read_b64_tr_b16 v[112:113], v240 offset:4096
    ds_read_b64_tr_b16 v[114:115], v240 offset:5120
    s_waitcnt lgkmcnt(14)
    v_mfma_f32_16x16x32_bf16 v[84:87], a[196:199], v[180:183], v[84:87]
    ds_read_b64_tr_b16 v[116:117], v241 offset:4096
    ds_read_b64_tr_b16 v[118:119], v241 offset:5120
    buffer_load_dwordx4 a[192:195], v8, s[8:11], s29 offen offset:2048 sc1
    s_waitcnt lgkmcnt(14)
    v_mfma_f32_16x16x32_bf16 v[88:91], a[196:199], v[184:187], v[88:91]
    ds_read_b64_tr_b16 v[120:121], v242 offset:4096
    ds_read_b64_tr_b16 v[122:123], v242 offset:5120
    s_waitcnt lgkmcnt(14)
    v_mfma_f32_16x16x32_bf16 v[92:95], a[196:199], v[188:191], v[92:95]
    ds_read_b64_tr_b16 v[124:125], v243 offset:4096
    ds_read_b64_tr_b16 v[126:127], v243 offset:5120
    global_load_dword v12, v11, s[68:69] sc1
    s_waitcnt lgkmcnt(14)
    v_mfma_f32_16x16x32_bf16 v[80:83], a[200:203], v[96:99], v[80:83]
    ds_read_b64_tr_b16 v[128:129], v240 offset:8192
    ds_read_b64_tr_b16 v[130:131], v240 offset:9216
    s_waitcnt lgkmcnt(14)
    v_mfma_f32_16x16x32_bf16 v[84:87], a[200:203], v[100:103], v[84:87]
    ds_read_b64_tr_b16 v[132:133], v241 offset:8192
    ds_read_b64_tr_b16 v[134:135], v241 offset:9216
    buffer_load_dwordx4 a[196:199], v8, s[8:11], s29 offen offset:3072 sc1
    s_waitcnt lgkmcnt(14)
    v_mfma_f32_16x16x32_bf16 v[88:91], a[200:203], v[104:107], v[88:91]
    ds_read_b64_tr_b16 v[136:137], v242 offset:8192
    ds_read_b64_tr_b16 v[138:139], v242 offset:9216
    s_waitcnt lgkmcnt(14)
    v_mfma_f32_16x16x32_bf16 v[92:95], a[200:203], v[108:111], v[92:95]
    ds_read_b64_tr_b16 v[140:141], v243 offset:8192
    ds_read_b64_tr_b16 v[142:143], v243 offset:9216
    s_waitcnt lgkmcnt(14)
    v_mfma_f32_16x16x32_bf16 v[80:83], a[204:207], v[112:115], v[80:83]
    ds_read_b64_tr_b16 v[144:145], v240 offset:12288
    ds_read_b64_tr_b16 v[146:147], v240 offset:13312
    s_waitcnt lgkmcnt(14)
    v_mfma_f32_16x16x32_bf16 v[84:87], a[204:207], v[116:119], v[84:87]
    ds_read_b64_tr_b16 v[148:149], v241 offset:12288
    ds_read_b64_tr_b16 v[150:151], v241 offset:13312
    s_mov_b32 s29, 57344
    buffer_load_dwordx4 a[200:203], v8, s[8:11], s29 offen offset:0 sc1
    s_waitcnt lgkmcnt(14)
    v_mfma_f32_16x16x32_bf16 v[88:91], a[204:207], v[120:123], v[88:91]
    ds_read_b64_tr_b16 v[152:153], v242 offset:12288
    ds_read_b64_tr_b16 v[154:155], v242 offset:13312
    s_waitcnt lgkmcnt(14)
    v_mfma_f32_16x16x32_bf16 v[92:95], a[204:207], v[124:127], v[92:95]
    ds_read_b64_tr_b16 v[156:157], v243 offset:12288
    ds_read_b64_tr_b16 v[158:159], v243 offset:13312
    s_waitcnt lgkmcnt(14)
    v_mfma_f32_16x16x32_bf16 v[80:83], a[208:211], v[128:131], v[80:83]
    s_waitcnt lgkmcnt(12)
    v_mfma_f32_16x16x32_bf16 v[84:87], a[208:211], v[132:135], v[84:87]
    buffer_load_dwordx4 a[204:207], v8, s[8:11], s29 offen offset:1024 sc1
    s_waitcnt lgkmcnt(10)
    v_mfma_f32_16x16x32_bf16 v[88:91], a[208:211], v[136:139], v[88:91]
    s_waitcnt lgkmcnt(8)
    v_mfma_f32_16x16x32_bf16 v[92:95], a[208:211], v[140:143], v[92:95]
    s_waitcnt lgkmcnt(6)
    v_mfma_f32_16x16x32_bf16 v[80:83], a[212:215], v[144:147], v[80:83]
    s_waitcnt lgkmcnt(4)
    v_mfma_f32_16x16x32_bf16 v[84:87], a[212:215], v[148:151], v[84:87]
    buffer_load_dwordx4 a[208:211], v8, s[8:11], s29 offen offset:2048 sc1
    s_waitcnt lgkmcnt(2)
    v_mfma_f32_16x16x32_bf16 v[88:91], a[212:215], v[152:155], v[88:91]
    s_waitcnt lgkmcnt(0)
    v_mfma_f32_16x16x32_bf16 v[92:95], a[212:215], v[156:159], v[92:95]
    s_waitcnt vmcnt(4)
    v_cmp_gt_u32 vcc, 1, v12
    s_cbranch_vccnz LF_spinh1
LF_goh1:
    s_add_u32 s79, s78, 0
    buffer_load_dwordx4 v[104:107], v4, s[12:15], s79 offen sc1
    buffer_load_dwordx4 v[108:111], v5, s[12:15], s79 offen sc1
    buffer_load_dwordx4 v[112:115], v6, s[12:15], s79 offen sc1
    buffer_load_dwordx4 v[116:119], v7, s[12:15], s79 offen sc1
    s_add_u32 s79, s78, 8192
    buffer_load_dwordx4 v[120:123], v4, s[12:15], s79 offen sc1
    buffer_load_dwordx4 v[124:127], v5, s[12:15], s79 offen sc1
    buffer_load_dwordx4 v[128:131], v6, s[12:15], s79 offen sc1
    buffer_load_dwordx4 v[132:135], v7, s[12:15], s79 offen sc1
    v_pk_fma_f32 v[80:81], v[40:41], v[16:17], v[80:81] op_sel_hi:[1,0,1] neg_lo:[1,0,0] neg_hi:[1,0,0]
    v_pk_fma_f32 v[82:83], v[42:43], v[16:17], v[82:83] op_sel_hi:[1,0,1] neg_lo:[1,0,0] neg_hi:[1,0,0]
    v_pk_fma_f32 v[84:85], v[40:41], v[18:19], v[84:85] op_sel_hi:[1,0,1] neg_lo:[1,0,0] neg_hi:[1,0,0]
    v_pk_fma_f32 v[86:87], v[42:43], v[18:19], v[86:87] op_sel_hi:[1,0,1] neg_lo:[1,0,0] neg_hi:[1,0,0]
    v_pk_fma_f32 v[88:89], v[40:41], v[20:21], v[88:89] op_sel_hi:[1,0,1] neg_lo:[1,0,0] neg_hi:[1,0,0]
    v_pk_fma_f32 v[90:91], v[42:43], v[20:21], v[90:91] op_sel_hi:[1,0,1] neg_lo:[1,0,0] neg_hi:[1,0,0]
    v_pk_fma_f32 v[92:93], v[40:41], v[22:23], v[92:93] op_sel_hi:[1,0,1] neg_lo:[1,0,0] neg_hi:[1,0,0]
    v_pk_fma_f32 v[94:95], v[42:43], v[22:23], v[94:95] op_sel_hi:[1,0,1] neg_lo:[1,0,0] neg_hi:[1,0,0]
    s_add_u32 s79, s78, 12288
    buffer_load_dwordx4 v[136:139], v4, s[12:15], s79 offen sc1
    v_pk_fma_f32 v[80:81], v[80:81], v[16:17], v[44:45] op_sel:[0,1,0] op_sel_hi:[1,1,1]
    v_pk_fma_f32 v[82:83], v[82:83], v[16:17], v[46:47] op_sel:[0,1,0] op_sel_hi:[1,1,1]
    v_pk_fma_f32 v[84:85], v[84:85], v[18:19], v[44:45] op_sel:[0,1,0] op_sel_hi:[1,1,1]
    v_pk_fma_f32 v[86:87], v[86:87], v[18:19], v[46:47] op_sel:[0,1,0] op_sel_hi:[1,1,1]
    v_pk_fma_f32 v[88:89], v[88:89], v[20:21], v[44:45] op_sel:[0,1,0] op_sel_hi:[1,1,1]
    v_pk_fma_f32 v[90:91], v[90:91], v[20:21], v[46:47] op_sel:[0,1,0] op_sel_hi:[1,1,1]
    v_pk_fma_f32 v[92:93], v[92:93], v[22:23], v[44:45] op_sel:[0,1,0] op_sel_hi:[1,1,1]
    v_pk_fma_f32 v[94:95], v[94:95], v[22:23], v[46:47] op_sel:[0,1,0] op_sel_hi:[1,1,1]
    buffer_load_dwordx4 v[140:143], v5, s[12:15], s79 offen sc1
    v_exp_f32 v192, v80
    v_exp_f32 v193, v81
    v_exp_f32 v194, v82
    v_exp_f32 v195, v83
    v_exp_f32 v196, v84
    v_exp_f32 v197, v85
    v_exp_f32 v198, v86
    v_exp_f32 v199, v87
    buffer_load_dwordx4 v[144:147], v6, s[12:15], s79 offen sc1
    v_exp_f32 v200, v88
    v_exp_f32 v201, v89
    v_exp_f32 v202, v90
    v_exp_f32 v203, v91
    v_exp_f32 v204, v92
    v_exp_f32 v205, v93
    v_exp_f32 v206, v94
    v_exp_f32 v207, v95
    buffer_load_dwordx4 v[148:151], v7, s[12:15], s79 offen sc1
    v_pk_add_f32 v[192:193], v[192:193], 1.0 op_sel_hi:[1,0]
    v_pk_add_f32 v[194:195], v[194:195], 1.0 op_sel_hi:[1,0]
    v_pk_add_f32 v[196:197], v[196:197], 1.0 op_sel_hi:[1,0]
    v_pk_add_f32 v[198:199], v[198:199], 1.0 op_sel_hi:[1,0]
    v_pk_add_f32 v[200:201], v[200:201], 1.0 op_sel_hi:[1,0]
    v_pk_add_f32 v[202:203], v[202:203], 1.0 op_sel_hi:[1,0]
    v_pk_add_f32 v[204:205], v[204:205], 1.0 op_sel_hi:[1,0]
    v_pk_add_f32 v[206:207], v[206:207], 1.0 op_sel_hi:[1,0]
    s_add_u32 s79, s78, 20480
    buffer_load_dwordx4 v[152:155], v4, s[12:15], s79 offen sc1
    v_rcp_f32 v192, v192
    v_rcp_f32 v193, v193
    v_rcp_f32 v194, v194
    v_rcp_f32 v195, v195
    v_rcp_f32 v196, v196
    v_rcp_f32 v197, v197
    v_rcp_f32 v198, v198
    v_rcp_f32 v199, v199
    buffer_load_dwordx4 v[156:159], v5, s[12:15], s79 offen sc1
    v_rcp_f32 v200, v200
    v_rcp_f32 v201, v201
    v_rcp_f32 v202, v202
    v_rcp_f32 v203, v203
    v_rcp_f32 v204, v204
    v_rcp_f32 v205, v205
    v_rcp_f32 v206, v206
    v_rcp_f32 v207, v207
    buffer_load_dwordx4 v[160:163], v6, s[12:15], s79 offen sc1
    v_pk_mul_f32 v[80:81], v[80:81], v[192:193]
    v_pk_mul_f32 v[82:83], v[82:83], v[194:195]
    v_pk_mul_f32 v[84:85], v[84:85], v[196:197]
    v_pk_mul_f32 v[86:87], v[86:87], v[198:199]
    v_pk_mul_f32 v[88:89], v[88:89], v[200:201]
    v_pk_mul_f32 v[90:91], v[90:91], v[202:203]
    v_pk_mul_f32 v[92:93], v[92:93], v[204:205]
    v_pk_mul_f32 v[94:95], v[94:95], v[206:207]
    buffer_load_dwordx4 v[164:167], v7, s[12:15], s79 offen sc1
    v_cvt_pk_bf16_f32 v208, v80, v81
    v_cvt_pk_bf16_f32 v209, v82, v83
    v_cvt_pk_bf16_f32 v210, v84, v85
    v_cvt_pk_bf16_f32 v211, v86, v87
    v_cvt_pk_bf16_f32 v212, v88, v89
    v_cvt_pk_bf16_f32 v213, v90, v91
    v_cvt_pk_bf16_f32 v214, v92, v93
    v_cvt_pk_bf16_f32 v215, v94, v95
    v_add_u32 v13, s80, v245
    ds_write_b64 v13, v[208:209]
    v_add_u32 v13, s81, v245
    ds_write_b64 v13, v[210:211]
    v_add_u32 v13, s82, v245
    ds_write_b64 v13, v[212:213]
    v_add_u32 v13, s83, v245
    ds_write_b64 v13, v[214:215]
    v_add_u32 v22, s80, v244
    v_add_u32 v23, s82, v244
    s_waitcnt lgkmcnt(0)
    s_barrier
    ds_read_b128 v[244:247], v22
    ds_read_b128 v[248:251], v23
    s_waitcnt lgkmcnt(1)
    buffer_store_dwordx4 v[244:247], v8, s[12:15], s76 offen sc1
    s_waitcnt lgkmcnt(0)
    buffer_store_dwordx4 v[248:251], v8, s[12:15], s77 offen sc1
    s_mov_b64 exec, 1
    global_store_dword v10, v15, s[68:69] sc1
    s_mov_b64 exec, -1
LF_g2:
    s_waitcnt vmcnt(18)
    v_mfma_f32_16x16x32_bf16 v[24:27], a[0:3], v[104:107], 0
    s_add_u32 s79, s78, 24576
    buffer_load_dwordx4 v[168:171], v4, s[12:15], s79 offen sc1
    v_mfma_f32_16x16x32_bf16 v[28:31], a[4:7], v[104:107], 0
    v_accvgpr_read_b32 v16, a240
    v_mfma_f32_16x16x32_bf16 v[32:35], a[8:11], v[104:107], 0
    buffer_load_dwordx4 v[172:175], v5, s[12:15], s79 offen sc1
    v_mfma_f32_16x16x32_bf16 v[36:39], a[12:15], v[104:107], 0
    v_accvgpr_read_b32 v17, a241
    v_mfma_f32_16x16x32_bf16 v[40:43], a[16:19], v[104:107], 0
    buffer_load_dwordx4 v[176:179], v6, s[12:15], s79 offen sc1
    s_waitcnt vmcnt(20)
    v_mfma_f32_16x16x32_bf16 v[44:47], a[0:3], v[108:111], 0
    buffer_load_dwordx4 v[180:183], v7, s[12:15], s79 offen sc1
    v_mfma_f32_16x16x32_bf16 v[48:51], a[4:7], v[108:111], 0
    v_accvgpr_read_b32 v18, a242
    v_mfma_f32_16x16x32_bf16 v[52:55], a[8:11], v[108:111], 0
    s_mov_b32 s29, 57344
    buffer_load_dwordx4 a[212:215], v8, s[8:11], s29 offen offset:3072 sc1
    v_mfma_f32_16x16x32_bf16 v[56:59], a[12:15], v[108:111], 0
    v_accvgpr_read_b32 v19, a243
    v_mfma_f32_16x16x32_bf16 v[60:63], a[16:19], v[108:111], 0
    v_accvgpr_read_b32 v20, a244
    s_waitcnt vmcnt(21)
    v_mfma_f32_16x16x32_bf16 v[64:67], a[0:3], v[112:115], 0
    v_accvgpr_read_b32 v21, a245
    v_mfma_f32_16x16x32_bf16 v[68:71], a[4:7], v[112:115], 0
    v_accvgpr_read_b32 v22, a246
    v_mfma_f32_16x16x32_bf16 v[72:75], a[8:11], v[112:115], 0
    v_accvgpr_read_b32 v252, a247
    v_mfma_f32_16x16x32_bf16 v[76:79], a[12:15], v[112:115], 0
    v_accvgpr_read_b32 v253, a248
    v_mfma_f32_16x16x32_bf16 v[80:83], a[16:19], v[112:115], 0
    v_accvgpr_read_b32 v254, a249
    s_waitcnt vmcnt(20)
    v_mfma_f32_16x16x32_bf16 v[84:87], a[0:3], v[116:119], 0
    v_mfma_f32_16x16x32_bf16 v[88:91], a[4:7], v[116:119], 0
    v_mfma_f32_16x16x32_bf16 v[92:95], a[8:11], v[116:119], 0
    v_mfma_f32_16x16x32_bf16 v[96:99], a[12:15], v[116:119], 0
    v_mfma_f32_16x16x32_bf16 v[100:103], a[16:19], v[116:119], 0
    s_waitcnt vmcnt(19)
    v_mfma_f32_16x16x32_bf16 v[24:27], a[20:23], v[120:123], v[24:27]
    s_add_u32 s79, s78, 32768
    buffer_load_dwordx4 v[184:187], v4, s[12:15], s79 offen sc1
    v_mfma_f32_16x16x32_bf16 v[28:31], a[24:27], v[120:123], v[28:31]
    v_mfma_f32_16x16x32_bf16 v[32:35], a[28:31], v[120:123], v[32:35]
    buffer_load_dwordx4 v[188:191], v5, s[12:15], s79 offen sc1
    v_mfma_f32_16x16x32_bf16 v[36:39], a[32:35], v[120:123], v[36:39]
    v_mfma_f32_16x16x32_bf16 v[40:43], a[36:39], v[120:123], v[40:43]
    buffer_load_dwordx4 v[192:195], v6, s[12:15], s79 offen sc1
    s_waitcnt vmcnt(21)
    v_mfma_f32_16x16x32_bf16 v[44:47], a[20:23], v[124:127], v[44:47]
    buffer_load_dwordx4 v[196:199], v7, s[12:15], s79 offen sc1
    v_mfma_f32_16x16x32_bf16 v[48:51], a[24:27], v[124:127], v[48:51]
    v_mfma_f32_16x16x32_bf16 v[52:55], a[28:31], v[124:127], v[52:55]
    v_mfma_f32_16x16x32_bf16 v[56:59], a[32:35], v[124:127], v[56:59]
    v_mfma_f32_16x16x32_bf16 v[60:63], a[36:39], v[124:127], v[60:63]
    s_waitcnt vmcnt(21)
    v_mfma_f32_16x16x32_bf16 v[64:67], a[20:23], v[128:131], v[64:67]
    v_mfma_f32_16x16x32_bf16 v[68:71], a[24:27], v[128:131], v[68:71]
    v_mfma_f32_16x16x32_bf16 v[72:75], a[28:31], v[128:131], v[72:75]
    v_mfma_f32_16x16x32_bf16 v[76:79], a[32:35], v[128:131], v[76:79]
    v_mfma_f32_16x16x32_bf16 v[80:83], a[36:39], v[128:131], v[80:83]
    s_waitcnt vmcnt(20)
    v_mfma_f32_16x16x32_bf16 v[84:87], a[20:23], v[132:135], v[84:87]
    v_mfma_f32_16x16x32_bf16 v[88:91], a[24:27], v[132:135], v[88:91]
    v_mfma_f32_16x16x32_bf16 v[92:95], a[28:31], v[132:135], v[92:95]
    v_mfma_f32_16x16x32_bf16 v[96:99], a[32:35], v[132:135], v[96:99]
    v_mfma_f32_16x16x32_bf16 v[100:103], a[36:39], v[132:135], v[100:103]
    s_waitcnt vmcnt(19)
    v_mfma_f32_16x16x32_bf16 v[24:27], a[40:43], v[136:139], v[24:27]
    s_add_u32 s79, s78, 36864
    buffer_load_dwordx4 v[200:203], v4, s[12:15], s79 offen sc1
    v_mfma_f32_16x16x32_bf16 v[28:31], a[44:47], v[136:139], v[28:31]
    v_mfma_f32_16x16x32_bf16 v[32:35], a[48:51], v[136:139], v[32:35]
    buffer_load_dwordx4 v[204:207], v5, s[12:15], s79 offen sc1
    v_mfma_f32_16x16x32_bf16 v[36:39], a[52:55], v[136:139], v[36:39]
    v_mfma_f32_16x16x32_bf16 v[40:43], a[56:59], v[136:139], v[40:43]
    buffer_load_dwordx4 v[208:211], v6, s[12:15], s79 offen sc1
    s_waitcnt vmcnt(21)
    v_mfma_f32_16x16x32_bf16 v[44:47], a[40:43], v[140:143], v[44:47]
    buffer_load_dwordx4 v[212:215], v7, s[12:15], s79 offen sc1
    v_mfma_f32_16x16x32_bf16 v[48:51], a[44:47], v[140:143], v[48:51]
    v_mfma_f32_16x16x32_bf16 v[52:55], a[48:51], v[140:143], v[52:55]
    global_load_dword v12, v11, s[68:69] sc1
    v_mfma_f32_16x16x32_bf16 v[56:59], a[52:55], v[140:143], v[56:59]
    v_mfma_f32_16x16x32_bf16 v[60:63], a[56:59], v[140:143], v[60:63]
    s_waitcnt vmcnt(22)
    v_mfma_f32_16x16x32_bf16 v[64:67], a[40:43], v[144:147], v[64:67]
    v_mfma_f32_16x16x32_bf16 v[68:71], a[44:47], v[144:147], v[68:71]
    v_mfma_f32_16x16x32_bf16 v[72:75], a[48:51], v[144:147], v[72:75]
    v_mfma_f32_16x16x32_bf16 v[76:79], a[52:55], v[144:147], v[76:79]
    v_mfma_f32_16x16x32_bf16 v[80:83], a[56:59], v[144:147], v[80:83]
    s_waitcnt vmcnt(21)
    v_mfma_f32_16x16x32_bf16 v[84:87], a[40:43], v[148:151], v[84:87]
    v_mfma_f32_16x16x32_bf16 v[88:91], a[44:47], v[148:151], v[88:91]
    v_mfma_f32_16x16x32_bf16 v[92:95], a[48:51], v[148:151], v[92:95]
    v_mfma_f32_16x16x32_bf16 v[96:99], a[52:55], v[148:151], v[96:99]
    v_mfma_f32_16x16x32_bf16 v[100:103], a[56:59], v[148:151], v[100:103]
    s_waitcnt vmcnt(20)
    v_mfma_f32_16x16x32_bf16 v[24:27], a[60:63], v[152:155], v[24:27]
    s_add_u32 s79, s78, 45056
    buffer_load_dwordx4 v[216:219], v4, s[12:15], s79 offen sc1
    v_mfma_f32_16x16x32_bf16 v[28:31], a[64:67], v[152:155], v[28:31]
    v_mfma_f32_16x16x32_bf16 v[32:35], a[68:71], v[152:155], v[32:35]
    buffer_load_dwordx4 v[220:223], v5, s[12:15], s79 offen sc1
    v_mfma_f32_16x16x32_bf16 v[36:39], a[72:75], v[152:155], v[36:39]
    v_mfma_f32_16x16x32_bf16 v[40:43], a[76:79], v[152:155], v[40:43]
    buffer_load_dwordx4 v[224:227], v6, s[12:15], s79 offen sc1
    s_waitcnt vmcnt(22)
    v_mfma_f32_16x16x32_bf16 v[44:47], a[60:63], v[156:159], v[44:47]
    buffer_load_dwordx4 v[228:231], v7, s[12:15], s79 offen sc1
    v_mfma_f32_16x16x32_bf16 v[48:51], a[64:67], v[156:159], v[48:51]
    v_mfma_f32_16x16x32_bf16 v[52:55], a[68:71], v[156:159], v[52:55]
    v_mfma_f32_16x16x32_bf16 v[56:59], a[72:75], v[156:159], v[56:59]
    v_mfma_f32_16x16x32_bf16 v[60:63], a[76:79], v[156:159], v[60:63]
    s_waitcnt vmcnt(22)
    v_mfma_f32_16x16x32_bf16 v[64:67], a[60:63], v[160:163], v[64:67]
    v_mfma_f32_16x16x32_bf16 v[68:71], a[64:67], v[160:163], v[68:71]
    v_mfma_f32_16x16x32_bf16 v[72:75], a[68:71], v[160:163], v[72:75]
    v_mfma_f32_16x16x32_bf16 v[76:79], a[72:75], v[160:163], v[76:79]
    v_mfma_f32_16x16x32_bf16 v[80:83], a[76:79], v[160:163], v[80:83]
    s_waitcnt vmcnt(21)
    v_mfma_f32_16x16x32_bf16 v[84:87], a[60:63], v[164:167], v[84:87]
    v_mfma_f32_16x16x32_bf16 v[88:91], a[64:67], v[164:167], v[88:91]
    v_mfma_f32_16x16x32_bf16 v[92:95], a[68:71], v[164:167], v[92:95]
    v_mfma_f32_16x16x32_bf16 v[96:99], a[72:75], v[164:167], v[96:99]
    v_mfma_f32_16x16x32_bf16 v[100:103], a[76:79], v[164:167], v[100:103]
    s_waitcnt vmcnt(4)
    v_cmp_gt_u32 vcc, 2, v12
    s_cbranch_vccnz LF_spinh2
LF_goh2:
    v_mfma_f32_16x16x32_bf16 v[24:27], a[80:83], v[168:171], v[24:27]
    s_add_u32 s79, s78, 4096
    buffer_load_dwordx4 v[108:111], v5, s[12:15], s79 offen sc1
    v_mfma_f32_16x16x32_bf16 v[28:31], a[84:87], v[168:171], v[28:31]
    v_mfma_f32_16x16x32_bf16 v[32:35], a[88:91], v[168:171], v[32:35]
    s_add_u32 s79, s78, 16384
    buffer_load_dwordx4 v[124:127], v5, s[12:15], s79 offen sc1
    v_mfma_f32_16x16x32_bf16 v[36:39], a[92:95], v[168:171], v[36:39]
    v_mfma_f32_16x16x32_bf16 v[40:43], a[96:99], v[168:171], v[40:43]
    s_add_u32 s79, s78, 28672
    buffer_load_dwordx4 v[140:143], v5, s[12:15], s79 offen sc1
    v_mfma_f32_16x16x32_bf16 v[44:47], a[80:83], v[172:175], v[44:47]
    s_add_u32 s79, s78, 40960
    buffer_load_dwordx4 v[156:159], v5, s[12:15], s79 offen sc1
    v_mfma_f32_16x16x32_bf16 v[48:51], a[84:87], v[172:175], v[48:51]
    v_mfma_f32_16x16x32_bf16 v[52:55], a[88:91], v[172:175], v[52:55]
    v_mfma_f32_16x16x32_bf16 v[56:59], a[92:95], v[172:175], v[56:59]
    v_mfma_f32_16x16x32_bf16 v[60:63], a[96:99], v[172:175], v[60:63]
    v_mfma_f32_16x16x32_bf16 v[64:67], a[80:83], v[176:179], v[64:67]
    v_mfma_f32_16x16x32_bf16 v[68:71], a[84:87], v[176:179], v[68:71]
    v_mfma_f32_16x16x32_bf16 v[72:75], a[88:91], v[176:179], v[72:75]
    v_mfma_f32_16x16x32_bf16 v[76:79], a[92:95], v[176:179], v[76:79]
    v_mfma_f32_16x16x32_bf16 v[80:83], a[96:99], v[176:179], v[80:83]
    v_mfma_f32_16x16x32_bf16 v[84:87], a[80:83], v[180:183], v[84:87]
    v_mfma_f32_16x16x32_bf16 v[88:91], a[84:87], v[180:183], v[88:91]
    v_mfma_f32_16x16x32_bf16 v[92:95], a[88:91], v[180:183], v[92:95]
    v_mfma_f32_16x16x32_bf16 v[96:99], a[92:95], v[180:183], v[96:99]
    v_mfma_f32_16x16x32_bf16 v[100:103], a[96:99], v[180:183], v[100:103]
    v_mfma_f32_16x16x32_bf16 v[24:27], a[100:103], v[184:187], v[24:27]
    s_add_u32 s79, s78, 4096
    buffer_load_dwordx4 v[112:115], v6, s[12:15], s79 offen sc1
    v_mfma_f32_16x16x32_bf16 v[28:31], a[104:107], v[184:187], v[28:31]
    v_mfma_f32_16x16x32_bf16 v[32:35], a[108:111], v[184:187], v[32:35]
    s_add_u32 s79, s78, 16384
    buffer_load_dwordx4 v[128:131], v6, s[12:15], s79 offen sc1
    v_mfma_f32_16x16x32_bf16 v[36:39], a[112:115], v[184:187], v[36:39]
    v_mfma_f32_16x16x32_bf16 v[40:43], a[116:119], v[184:187], v[40:43]
    s_add_u32 s79, s78, 28672
    buffer_load_dwordx4 v[144:147], v6, s[12:15], s79 offen sc1
    v_mfma_f32_16x16x32_bf16 v[44:47], a[100:103], v[188:191], v[44:47]
    s_add_u32 s79, s78, 40960
    buffer_load_dwordx4 v[160:163], v6, s[12:15], s79 offen sc1
    v_mfma_f32_16x16x32_bf16 v[48:51], a[104:107], v[188:191], v[48:51]
    v_mfma_f32_16x16x32_bf16 v[52:55], a[108:111], v[188:191], v[52:55]
    v_mfma_f32_16x16x32_bf16 v[56:59], a[112:115], v[188:191], v[56:59]
    v_mfma_f32_16x16x32_bf16 v[60:63], a[116:119], v[188:191], v[60:63]
    v_mfma_f32_16x16x32_bf16 v[64:67], a[100:103], v[192:195], v[64:67]
    v_mfma_f32_16x16x32_bf16 v[68:71], a[104:107], v[192:195], v[68:71]
    v_mfma_f32_16x16x32_bf16 v[72:75], a[108:111], v[192:195], v[72:75]
    v_mfma_f32_16x16x32_bf16 v[76:79], a[112:115], v[192:195], v[76:79]
    v_mfma_f32_16x16x32_bf16 v[80:83], a[116:119], v[192:195], v[80:83]
    v_mfma_f32_16x16x32_bf16 v[84:87], a[100:103], v[196:199], v[84:87]
    v_mfma_f32_16x16x32_bf16 v[88:91], a[104:107], v[196:199], v[88:91]
    v_mfma_f32_16x16x32_bf16 v[92:95], a[108:111], v[196:199], v[92:95]
    v_mfma_f32_16x16x32_bf16 v[96:99], a[112:115], v[196:199], v[96:99]
    v_mfma_f32_16x16x32_bf16 v[100:103], a[116:119], v[196:199], v[100:103]
    v_mfma_f32_16x16x32_bf16 v[24:27], a[120:123], v[200:203], v[24:27]
    s_add_u32 s79, s78, 4096
    buffer_load_dwordx4 v[116:119], v7, s[12:15], s79 offen sc1
    v_mfma_f32_16x16x32_bf16 v[28:31], a[124:127], v[200:203], v[28:31]
    v_mfma_f32_16x16x32_bf16 v[32:35], a[128:131], v[200:203], v[32:35]
    s_add_u32 s79, s78, 16384
    buffer_load_dwordx4 v[132:135], v7, s[12:15], s79 offen sc1
    v_mfma_f32_16x16x32_bf16 v[36:39], a[132:135], v[200:203], v[36:39]
    v_mfma_f32_16x16x32_bf16 v[40:43], a[136:139], v[200:203], v[40:43]
    s_add_u32 s79, s78, 28672
    buffer_load_dwordx4 v[148:151], v7, s[12:15], s79 offen sc1
    v_mfma_f32_16x16x32_bf16 v[44:47], a[120:123], v[204:207], v[44:47]
    s_add_u32 s79, s78, 40960
    buffer_load_dwordx4 v[164:167], v7, s[12:15], s79 offen sc1
    v_mfma_f32_16x16x32_bf16 v[48:51], a[124:127], v[204:207], v[48:51]
    v_mfma_f32_16x16x32_bf16 v[52:55], a[128:131], v[204:207], v[52:55]
    v_mfma_f32_16x16x32_bf16 v[56:59], a[132:135], v[204:207], v[56:59]
    v_mfma_f32_16x16x32_bf16 v[60:63], a[136:139], v[204:207], v[60:63]
    v_mfma_f32_16x16x32_bf16 v[64:67], a[120:123], v[208:211], v[64:67]
    v_mfma_f32_16x16x32_bf16 v[68:71], a[124:127], v[208:211], v[68:71]
    v_mfma_f32_16x16x32_bf16 v[72:75], a[128:131], v[208:211], v[72:75]
    v_mfma_f32_16x16x32_bf16 v[76:79], a[132:135], v[208:211], v[76:79]
    v_mfma_f32_16x16x32_bf16 v[80:83], a[136:139], v[208:211], v[80:83]
    v_mfma_f32_16x16x32_bf16 v[84:87], a[120:123], v[212:215], v[84:87]
    v_mfma_f32_16x16x32_bf16 v[88:91], a[124:127], v[212:215], v[88:91]
    v_mfma_f32_16x16x32_bf16 v[92:95], a[128:131], v[212:215], v[92:95]
    v_mfma_f32_16x16x32_bf16 v[96:99], a[132:135], v[212:215], v[96:99]
    v_mfma_f32_16x16x32_bf16 v[100:103], a[136:139], v[212:215], v[100:103]
    s_waitcnt vmcnt(15)
    v_mfma_f32_16x16x32_bf16 v[24:27], a[140:143], v[216:219], v[24:27]
    s_add_u32 s79, s78, 4096
    buffer_load_dwordx4 v[104:107], v4, s[12:15], s79 offen sc1
    v_mfma_f32_16x16x32_bf16 v[28:31], a[144:147], v[216:219], v[28:31]
    v_mfma_f32_16x16x32_bf16 v[32:35], a[148:151], v[216:219], v[32:35]
    s_add_u32 s79, s78, 16384
    buffer_load_dwordx4 v[120:123], v4, s[12:15], s79 offen sc1
    v_mfma_f32_16x16x32_bf16 v[36:39], a[152:155], v[216:219], v[36:39]
    v_mfma_f32_16x16x32_bf16 v[40:43], a[156:159], v[216:219], v[40:43]
    s_add_u32 s79, s78, 28672
    buffer_load_dwordx4 v[136:139], v4, s[12:15], s79 offen sc1
    s_waitcnt vmcnt(17)
    v_mfma_f32_16x16x32_bf16 v[44:47], a[140:143], v[220:223], v[44:47]
    s_add_u32 s79, s78, 40960
    buffer_load_dwordx4 v[152:155], v4, s[12:15], s79 offen sc1
    v_mfma_f32_16x16x32_bf16 v[48:51], a[144:147], v[220:223], v[48:51]
    v_mfma_f32_16x16x32_bf16 v[52:55], a[148:151], v[220:223], v[52:55]
    v_mfma_f32_16x16x32_bf16 v[56:59], a[152:155], v[220:223], v[56:59]
    v_mfma_f32_16x16x32_bf16 v[60:63], a[156:159], v[220:223], v[60:63]
    s_waitcnt vmcnt(17)
    v_mfma_f32_16x16x32_bf16 v[64:67], a[140:143], v[224:227], v[64:67]
    v_mfma_f32_16x16x32_bf16 v[68:71], a[144:147], v[224:227], v[68:71]
    v_mfma_f32_16x16x32_bf16 v[72:75], a[148:151], v[224:227], v[72:75]
    v_mfma_f32_16x16x32_bf16 v[76:79], a[152:155], v[224:227], v[76:79]
    v_mfma_f32_16x16x32_bf16 v[80:83], a[156:159], v[224:227], v[80:83]
    s_waitcnt vmcnt(16)
    v_mfma_f32_16x16x32_bf16 v[84:87], a[140:143], v[228:231], v[84:87]
    v_mfma_f32_16x16x32_bf16 v[88:91], a[144:147], v[228:231], v[88:91]
    v_mfma_f32_16x16x32_bf16 v[92:95], a[148:151], v[228:231], v[92:95]
    v_mfma_f32_16x16x32_bf16 v[96:99], a[152:155], v[228:231], v[96:99]
    v_mfma_f32_16x16x32_bf16 v[100:103], a[156:159], v[228:231], v[100:103]
    s_waitcnt vmcnt(15)
    v_mfma_f32_16x16x32_bf16 v[44:47], a[216:219], v[108:111], v[44:47]
    v_accvgpr_read_b32 v5, a250
    v_accvgpr_read_b32 v6, a251
    v_mfma_f32_16x16x32_bf16 v[48:51], a[220:223], v[108:111], v[48:51]
    v_accvgpr_read_b32 v7, a252
    ds_read_b64_tr_b16 v[192:193], v16 offset:0
    v_mfma_f32_16x16x32_bf16 v[52:55], a[224:227], v[108:111], v[52:55]
    ds_read_b64_tr_b16 v[194:195], v16 offset:2048
    ds_read_b64_tr_b16 v[196:197], v16 offset:4096
    v_mfma_f32_16x16x32_bf16 v[56:59], a[228:231], v[108:111], v[56:59]
    ds_read_b64_tr_b16 v[198:199], v16 offset:6144
    ds_read_b64_tr_b16 v[200:201], v16 offset:8192
    v_mfma_f32_16x16x32_bf16 v[60:63], a[232:235], v[108:111], v[60:63]
    ds_read_b128 v[232:235], v22 offset:0
    ds_read_b128 v[236:239], v22 offset:64
    s_waitcnt vmcnt(14)
    v_mfma_f32_16x16x32_bf16 v[44:47], a[236:239], v[124:127], v[44:47]
    ds_read_b128 v[240:243], v22 offset:128
    ds_read_b128 v[244:247], v22 offset:192
    v_mfma_f32_16x16x32_bf16 v[48:51], a[160:163], v[124:127], v[48:51]
    ds_read_b128 v[248:251], v22 offset:256
    s_waitcnt lgkmcnt(9)
    v_lshlrev_b32 v168, 16, v192
    v_mfma_f32_16x16x32_bf16 v[52:55], a[164:167], v[124:127], v[52:55]
    v_and_b32 v169, 0xffff0000, v192
    v_lshlrev_b32 v170, 16, v193
    v_mfma_f32_16x16x32_bf16 v[56:59], a[168:171], v[124:127], v[56:59]
    v_and_b32 v171, 0xffff0000, v193
    s_waitcnt lgkmcnt(8)
    v_lshlrev_b32 v172, 16, v194
    v_mfma_f32_16x16x32_bf16 v[60:63], a[172:175], v[124:127], v[60:63]
    v_and_b32 v173, 0xffff0000, v194
    v_lshlrev_b32 v174, 16, v195
    s_waitcnt vmcnt(13)
    v_mfma_f32_16x16x32_bf16 v[44:47], a[176:179], v[140:143], v[44:47]
    v_and_b32 v175, 0xffff0000, v195
    s_waitcnt lgkmcnt(7)
    v_lshlrev_b32 v176, 16, v196
    v_mfma_f32_16x16x32_bf16 v[48:51], a[180:183], v[140:143], v[48:51]
    v_and_b32 v177, 0xffff0000, v196
    v_lshlrev_b32 v178, 16, v197
    v_mfma_f32_16x16x32_bf16 v[52:55], a[184:187], v[140:143], v[52:55]
    v_and_b32 v179, 0xffff0000, v197
    s_waitcnt lgkmcnt(6)
    v_lshlrev_b32 v180, 16, v198
    v_mfma_f32_16x16x32_bf16 v[56:59], a[188:191], v[140:143], v[56:59]
    v_and_b32 v181, 0xffff0000, v198
    v_lshlrev_b32 v182, 16, v199
    v_mfma_f32_16x16x32_bf16 v[60:63], a[192:195], v[140:143], v[60:63]
    v_and_b32 v183, 0xffff0000, v199
    s_waitcnt lgkmcnt(5)
    v_lshlrev_b32 v184, 16, v200
    s_waitcnt vmcnt(12)
    v_mfma_f32_16x16x32_bf16 v[44:47], a[196:199], v[156:159], v[44:47]
    v_and_b32 v185, 0xffff0000, v200
    v_lshlrev_b32 v186, 16, v201
    v_mfma_f32_16x16x32_bf16 v[48:51], a[200:203], v[156:159], v[48:51]
    v_and_b32 v187, 0xffff0000, v201
    v_mfma_f32_16x16x32_bf16 v[52:55], a[204:207], v[156:159], v[52:55]
    v_mfma_f32_16x16x32_bf16 v[56:59], a[208:211], v[156:159], v[56:59]
    v_mfma_f32_16x16x32_bf16 v[60:63], a[212:215], v[156:159], v[60:63]
    s_waitcnt vmcnt(11)
    v_mfma_f32_16x16x32_bf16 v[64:67], a[216:219], v[112:115], v[64:67]
    v_mfma_f32_16x16x32_bf16 v[68:71], a[220:223], v[112:115], v[68:71]
    v_mfma_f32_16x16x32_bf16 v[72:75], a[224:227], v[112:115], v[72:75]
    v_mfma_f32_16x16x32_bf16 v[76:79], a[228:231], v[112:115], v[76:79]
    ds_write_b128 v5, v[44:47] offset:0
    v_mfma_f32_16x16x32_bf16 v[80:83], a[232:235], v[112:115], v[80:83]
    s_waitcnt vmcnt(10)
    v_mfma_f32_16x16x32_bf16 v[64:67], a[236:239], v[128:131], v[64:67]
    v_mfma_f32_16x16x32_bf16 v[68:71], a[160:163], v[128:131], v[68:71]
    ds_write_b128 v5, v[48:51] offset:1024
    v_mfma_f32_16x16x32_bf16 v[72:75], a[164:167], v[128:131], v[72:75]
    v_mfma_f32_16x16x32_bf16 v[76:79], a[168:171], v[128:131], v[76:79]
    v_mfma_f32_16x16x32_bf16 v[80:83], a[172:175], v[128:131], v[80:83]
    ds_write_b128 v5, v[52:55] offset:2048
    s_waitcnt vmcnt(9)
    v_mfma_f32_16x16x32_bf16 v[64:67], a[176:179], v[144:147], v[64:67]
    v_mfma_f32_16x16x32_bf16 v[68:71], a[180:183], v[144:147], v[68:71]
    v_mfma_f32_16x16x32_bf16 v[72:75], a[184:187], v[144:147], v[72:75]
    ds_write_b128 v5, v[56:59] offset:3072
    v_mfma_f32_16x16x32_bf16 v[76:79], a[188:191], v[144:147], v[76:79]
    v_mfma_f32_16x16x32_bf16 v[80:83], a[192:195], v[144:147], v[80:83]
    s_waitcnt vmcnt(8)
    v_mfma_f32_16x16x32_bf16 v[64:67], a[196:199], v[160:163], v[64:67]
    ds_write_b128 v5, v[60:63] offset:4096
    v_mfma_f32_16x16x32_bf16 v[68:71], a[200:203], v[160:163], v[68:71]
    v_mfma_f32_16x16x32_bf16 v[72:75], a[204:207], v[160:163], v[72:75]
    v_mfma_f32_16x16x32_bf16 v[76:79], a[208:211], v[160:163], v[76:79]
    v_mfma_f32_16x16x32_bf16 v[80:83], a[212:215], v[160:163], v[80:83]
    s_waitcnt vmcnt(7)
    v_mfma_f32_16x16x32_bf16 v[84:87], a[216:219], v[116:119], v[84:87]
    v_mfma_f32_16x16x32_bf16 v[88:91], a[220:223], v[116:119], v[88:91]
    v_mfma_f32_16x16x32_bf16 v[92:95], a[224:227], v[116:119], v[92:95]
    v_mfma_f32_16x16x32_bf16 v[96:99], a[228:231], v[116:119], v[96:99]
    ds_write_b128 v6, v[64:67] offset:0
    v_mfma_f32_16x16x32_bf16 v[100:103], a[232:235], v[116:119], v[100:103]
    s_waitcnt vmcnt(6)
    v_mfma_f32_16x16x32_bf16 v[84:87], a[236:239], v[132:135], v[84:87]
    v_mfma_f32_16x16x32_bf16 v[88:91], a[160:163], v[132:135], v[88:91]
    ds_write_b128 v6, v[68:71] offset:1024
    v_mfma_f32_16x16x32_bf16 v[92:95], a[164:167], v[132:135], v[92:95]
    v_mfma_f32_16x16x32_bf16 v[96:99], a[168:171], v[132:135], v[96:99]
    v_mfma_f32_16x16x32_bf16 v[100:103], a[172:175], v[132:135], v[100:103]
    ds_write_b128 v6, v[72:75] offset:2048
    s_waitcnt vmcnt(5)
    v_mfma_f32_16x16x32_bf16 v[84:87], a[176:179], v[148:151], v[84:87]
    v_mfma_f32_16x16x32_bf16 v[88:91], a[180:183], v[148:151], v[88:91]
    v_mfma_f32_16x16x32_bf16 v[92:95], a[184:187], v[148:151], v[92:95]
    ds_write_b128 v6, v[76:79] offset:3072
    v_mfma_f32_16x16x32_bf16 v[96:99], a[188:191], v[148:151], v[96:99]
    v_mfma_f32_16x16x32_bf16 v[100:103], a[192:195], v[148:151], v[100:103]
    s_waitcnt vmcnt(4)
    v_mfma_f32_16x16x32_bf16 v[84:87], a[196:199], v[164:167], v[84:87]
    ds_write_b128 v6, v[80:83] offset:4096
    v_mfma_f32_16x16x32_bf16 v[88:91], a[200:203], v[164:167], v[88:91]
    v_mfma_f32_16x16x32_bf16 v[92:95], a[204:207], v[164:167], v[92:95]
    v_mfma_f32_16x16x32_bf16 v[96:99], a[208:211], v[164:167], v[96:99]
    v_mfma_f32_16x16x32_bf16 v[100:103], a[212:215], v[164:167], v[100:103]
    s_waitcnt vmcnt(3)
    v_mfma_f32_16x16x32_bf16 v[24:27], a[216:219], v[104:107], v[24:27]
    v_mfma_f32_16x16x32_bf16 v[28:31], a[220:223], v[104:107], v[28:31]
    v_mfma_f32_16x16x32_bf16 v[32:35], a[224:227], v[104:107], v[32:35]
    v_mfma_f32_16x16x32_bf16 v[36:39], a[228:231], v[104:107], v[36:39]
    ds_write_b128 v7, v[84:87] offset:0
    v_mfma_f32_16x16x32_bf16 v[40:43], a[232:235], v[104:107], v[40:43]
    s_waitcnt vmcnt(2)
    v_mfma_f32_16x16x32_bf16 v[24:27], a[236:239], v[120:123], v[24:27]
    v_mfma_f32_16x16x32_bf16 v[28:31], a[160:163], v[120:123], v[28:31]
    ds_write_b128 v7, v[88:91] offset:1024
    v_mfma_f32_16x16x32_bf16 v[32:35], a[164:167], v[120:123], v[32:35]
    v_mfma_f32_16x16x32_bf16 v[36:39], a[168:171], v[120:123], v[36:39]
    v_mfma_f32_16x16x32_bf16 v[40:43], a[172:175], v[120:123], v[40:43]
    ds_write_b128 v7, v[92:95] offset:2048
    s_waitcnt vmcnt(1)
    v_mfma_f32_16x16x32_bf16 v[24:27], a[176:179], v[136:139], v[24:27]
    v_mfma_f32_16x16x32_bf16 v[28:31], a[180:183], v[136:139], v[28:31]
    v_mfma_f32_16x16x32_bf16 v[32:35], a[184:187], v[136:139], v[32:35]
    ds_write_b128 v7, v[96:99] offset:3072
    v_mfma_f32_16x16x32_bf16 v[36:39], a[188:191], v[136:139], v[36:39]
    v_mfma_f32_16x16x32_bf16 v[40:43], a[192:195], v[136:139], v[40:43]
    s_waitcnt vmcnt(0)
    v_mfma_f32_16x16x32_bf16 v[24:27], a[196:199], v[152:155], v[24:27]
    ds_write_b128 v7, v[100:103] offset:4096
    v_mfma_f32_16x16x32_bf16 v[28:31], a[200:203], v[152:155], v[28:31]
    v_mfma_f32_16x16x32_bf16 v[32:35], a[204:207], v[152:155], v[32:35]
    v_mfma_f32_16x16x32_bf16 v[36:39], a[208:211], v[152:155], v[36:39]
    v_mfma_f32_16x16x32_bf16 v[40:43], a[212:215], v[152:155], v[40:43]
    v_add_f32 v12, v44, v64
    v_add_f32 v12, v12, v84
    s_nop 0
    v_add_f32 v12, v12, v24
    s_cmp_lt_u32 s92, 3
    s_cselect_b64 s[30:31], -1, 0
    v_cmp_u_f32 vcc, v12, v12
    s_nop 0
    s_and_b64 vcc, vcc, s[30:31]
    s_cbranch_vccnz LF_g2redo
    s_waitcnt lgkmcnt(0)
    s_barrier
    ds_read_b128 v[44:47], v18 offset:0
    ds_read_b128 v[64:67], v18 offset:5120
    ds_read_b128 v[84:87], v18 offset:10240
    ds_read_b128 v[48:51], v18 offset:1024
    ds_read_b128 v[68:71], v18 offset:6144
    ds_read_b128 v[88:91], v18 offset:11264
    ds_read_b128 v[52:55], v18 offset:2048
    ds_read_b128 v[72:75], v18 offset:7168
    ds_read_b128 v[92:95], v18 offset:12288
    ds_read_b128 v[56:59], v18 offset:3072
    ds_read_b128 v[76:79], v18 offset:8192
    ds_read_b128 v[96:99], v18 offset:13312
    ds_read_b128 v[60:63], v18 offset:4096
    ds_read_b128 v[80:83], v18 offset:9216
    ds_read_b128 v[100:103], v18 offset:14336
    s_waitcnt lgkmcnt(14)
    v_pk_add_f32 v[24:25], v[24:25], v[44:45]
    s_waitcnt lgkmcnt(12)
    v_pk_add_f32 v[64:65], v[64:65], v[84:85]
    v_pk_add_f32 v[26:27], v[26:27], v[46:47]
    v_pk_add_f32 v[66:67], v[66:67], v[86:87]
    v_pk_add_f32 v[24:25], v[24:25], v[64:65]
    v_pk_add_f32 v[26:27], v[26:27], v[66:67]
    v_pk_fma_f32 v[24:25], v[24:25], v[232:233], v[168:169]
    v_pk_fma_f32 v[26:27], v[26:27], v[234:235], v[170:171]
    v_cvt_pk_bf16_f32 v104, v24, v25
    v_cvt_pk_bf16_f32 v105, v26, v27
    s_waitcnt lgkmcnt(11)
    v_pk_add_f32 v[28:29], v[28:29], v[48:49]
    s_waitcnt lgkmcnt(9)
    v_pk_add_f32 v[68:69], v[68:69], v[88:89]
    v_pk_add_f32 v[30:31], v[30:31], v[50:51]
    v_pk_add_f32 v[70:71], v[70:71], v[90:91]
    v_pk_add_f32 v[28:29], v[28:29], v[68:69]
    v_pk_add_f32 v[30:31], v[30:31], v[70:71]
    v_pk_fma_f32 v[28:29], v[28:29], v[236:237], v[172:173]
    v_pk_fma_f32 v[30:31], v[30:31], v[238:239], v[174:175]
    v_cvt_pk_bf16_f32 v106, v28, v29
    v_cvt_pk_bf16_f32 v107, v30, v31
    s_waitcnt lgkmcnt(8)
    v_pk_add_f32 v[32:33], v[32:33], v[52:53]
    s_waitcnt lgkmcnt(6)
    v_pk_add_f32 v[72:73], v[72:73], v[92:93]
    v_pk_add_f32 v[34:35], v[34:35], v[54:55]
    v_pk_add_f32 v[74:75], v[74:75], v[94:95]
    v_pk_add_f32 v[32:33], v[32:33], v[72:73]
    v_pk_add_f32 v[34:35], v[34:35], v[74:75]
    v_pk_fma_f32 v[32:33], v[32:33], v[240:241], v[176:177]
    v_pk_fma_f32 v[34:35], v[34:35], v[242:243], v[178:179]
    v_cvt_pk_bf16_f32 v108, v32, v33
    v_cvt_pk_bf16_f32 v109, v34, v35
    s_waitcnt lgkmcnt(5)
    v_pk_add_f32 v[36:37], v[36:37], v[56:57]
    s_waitcnt lgkmcnt(3)
    v_pk_add_f32 v[76:77], v[76:77], v[96:97]
    v_pk_add_f32 v[38:39], v[38:39], v[58:59]
    v_pk_add_f32 v[78:79], v[78:79], v[98:99]
    v_pk_add_f32 v[36:37], v[36:37], v[76:77]
    v_pk_add_f32 v[38:39], v[38:39], v[78:79]
    v_pk_fma_f32 v[36:37], v[36:37], v[244:245], v[180:181]
    v_pk_fma_f32 v[38:39], v[38:39], v[246:247], v[182:183]
    v_cvt_pk_bf16_f32 v110, v36, v37
    v_cvt_pk_bf16_f32 v111, v38, v39
    s_waitcnt lgkmcnt(2)
    v_pk_add_f32 v[40:41], v[40:41], v[60:61]
    s_waitcnt lgkmcnt(0)
    v_pk_add_f32 v[80:81], v[80:81], v[100:101]
    v_pk_add_f32 v[42:43], v[42:43], v[62:63]
    v_pk_add_f32 v[82:83], v[82:83], v[102:103]
    v_pk_add_f32 v[40:41], v[40:41], v[80:81]
    v_pk_add_f32 v[42:43], v[42:43], v[82:83]
    v_pk_fma_f32 v[40:41], v[40:41], v[248:249], v[184:185]
    v_pk_fma_f32 v[42:43], v[42:43], v[250:251], v[186:187]
    v_cvt_pk_bf16_f32 v112, v40, v41
    v_cvt_pk_bf16_f32 v113, v42, v43
    ds_write_b64 v17, v[104:105] offset:0
    ds_write_b64 v17, v[106:107] offset:32
    ds_write_b64 v17, v[108:109] offset:64
    ds_write_b64 v17, v[110:111] offset:96
    ds_write_b64 v17, v[112:113] offset:128
    ds_read_b128 v[44:47], v19
    ds_read_b128 v[48:51], v20
    ds_read_b128 v[52:55], v21
    s_waitcnt lgkmcnt(2)
    buffer_store_dwordx4 v[44:47], v252, s[16:19], s94 offen
    s_waitcnt lgkmcnt(1)
    buffer_store_dwordx4 v[48:51], v253, s[16:19], s94 offen
    s_waitcnt lgkmcnt(0)
    buffer_store_dwordx4 v[52:55], v254, s[16:19], s94 offen
    s_endpgm
LF_end:
    s_endpgm
LF_pol1:
    s_cmp_eq_u32 s21, 0
    s_cbranch_scc0 LF_noarr1
    global_load_dword v122, v123, s[68:69] sc1
    s_branch LF_noarr1
LF_spininit:
    s_mov_b32 s30, 40000
LF_spinlinit:
    global_load_dword v122, v123, s[66:67] sc1
    s_waitcnt vmcnt(0)
    v_cmp_gt_u32 vcc, 32, v122
    s_cbranch_vccz LF_goinit
    s_sleep 2
    s_sub_u32 s30, s30, 1
    s_cmp_lg_u32 s30, 0
    s_cbranch_scc1 LF_spinlinit
    s_branch LF_goinit
LF_arr1:
    s_waitcnt vmcnt(0)
    v_cmp_gt_u32 vcc, 32, v122
    s_cbranch_vccnz LF_spininit
LF_goinit:
    s_barrier
    s_cmp_eq_u32 s21, 0
    s_cbranch_scc0 LF_arr1b
    s_and_b32 s26, s2, 31
    s_lshl_b32 s26, s26, 7
    s_add_u32 s26, s26, 196608
    v_lshl_add_u32 v122, v1, 12, s26
    v_mov_b32 v133, 1
    s_mov_b64 exec, 0xff
    global_atomic_add v122, v133, s[68:69] sc1
    s_mov_b64 exec, -1
LF_arr1b:
    s_and_b32 s26, s2, 7
    s_lshl_b32 s26, s26, 12
    s_add_u32 s26, s26, 131072
    v_and_b32 v123, 31, v1
    v_lshl_add_u32 v123, v123, 7, s26
    v_lshrrev_b32 v133, 5, v1
    v_lshl_add_u32 v123, v133, 16, v123
    v_cmp_lt_u32 vcc, 31, v1
    s_nop 1
    v_cndmask_b32 v133, 8, 5, vcc
    s_mov_b32 s3, 2
    s_branch LF_kpass
LF_pol2:
    s_cmp_eq_u32 s21, 0
    s_cbranch_scc0 LF_nopoll1
    global_load_dword v155, v123, s[68:69] sc1
    s_branch LF_nopoll1
LF_spins1:
    s_mov_b32 s30, 40000
LF_spinls1:
    global_load_dword v122, v123, s[68:69] sc1
    s_waitcnt vmcnt(0)
    v_cmp_gt_u32 vcc, v133, v122
    s_cbranch_vccz LF_gos1
    s_sleep 2
    s_sub_u32 s30, s30, 1
    s_cmp_lg_u32 s30, 0
    s_cbranch_scc1 LF_spinls1
    s_branch LF_gos1
LF_spininit2:
    s_mov_b32 s30, 40000
LF_spinlinit2:
    global_load_dword v122, v123, s[66:67] sc1
    s_waitcnt vmcnt(0)
    v_cmp_gt_u32 vcc, 32, v122
    s_cbranch_vccz LF_goinit2
    s_sleep 2
    s_sub_u32 s30, s30, 1
    s_cmp_lg_u32 s30, 0
    s_cbranch_scc1 LF_spinlinit2
    s_branch LF_goinit2
LF_spininit3:
    s_mov_b32 s30, 40000
LF_spinlinit3:
    global_load_dword v122, v123, s[66:67] sc1
    s_waitcnt vmcnt(0)
    v_cmp_gt_u32 vcc, 32, v122
    s_cbranch_vccz LF_goinit3
    s_sleep 2
    s_sub_u32 s30, s30, 1
    s_cmp_lg_u32 s30, 0
    s_cbranch_scc1 LF_spinlinit3
    s_branch LF_goinit3
LF_init:
    s_sub_u32 s24, s20, 80
    s_lshl_b32 s24, s24, 1
    s_add_u32 s24, s24, s21
    s_sub_u32 s24, s24, 2
    s_lshl_b32 s24, s24, 12
    s_add_u32 s24, s24, 131072
    v_add_u32 v30, s24, v8
    v_mov_b32 v26, 0
    v_mov_b32 v27, 0
    v_mov_b32 v28, 0
    v_mov_b32 v29, 0
    global_store_dwordx4 v30, v[26:29], s[68:69] sc1
    global_store_dwordx4 v30, v[26:29], s[68:69] offset:1024 sc1
    global_store_dwordx4 v30, v[26:29], s[68:69] offset:2048 sc1
    global_store_dwordx4 v30, v[26:29], s[68:69] offset:3072 sc1
    v_mov_b32 v31, 1
    s_waitcnt vmcnt(0)
    s_mov_b64 exec, 1
    global_atomic_add v26, v31, s[66:67] sc1
    s_mov_b64 exec, -1
    s_cmp_eq_u32 s21, 3
    s_cbranch_scc1 LF_sa_w1
    s_branch LF_sa_end
LF_spinsm:
    s_mov_b32 s30, 40000
LF_spinlsm:
    global_load_dword v122, v123, s[68:69] sc1
    s_waitcnt vmcnt(0)
    v_cmp_gt_u32 vcc, v133, v122
    s_cbranch_vccz LF_gosm
    s_sleep 8
    s_sub_u32 s30, s30, 1
    s_cmp_lg_u32 s30, 0
    s_cbranch_scc1 LF_spinlsm
    s_branch LF_gosm
LF_spinsmg:
    s_mov_b32 s30, 40000
LF_spinlsmg:
    global_load_dword v122, v123, s[68:69] sc1
    s_waitcnt vmcnt(0)
    v_cmp_gt_u32 vcc, 5, v122
    s_cbranch_vccz LF_gosmg
    s_sleep 2
    s_sub_u32 s30, s30, 1
    s_cmp_lg_u32 s30, 0
    s_cbranch_scc1 LF_spinlsmg
    s_branch LF_gosmg
LF_spinf1:
    s_mov_b32 s30, 40000
LF_spinlf1:
    global_load_dword v250, v251, s[68:69] sc1
    s_waitcnt vmcnt(0)
    v_cmp_gt_u32 vcc, 1, v250
    s_cbranch_vccz LF_gof1
    s_sleep 2
    s_sub_u32 s30, s30, 1
    s_cmp_lg_u32 s30, 0
    s_cbranch_scc1 LF_spinlf1
    s_branch LF_gof1
LF_spins2:
    s_mov_b32 s30, 40000
LF_spinls2:
    global_load_dword v12, v13, s[68:69] sc1
    s_waitcnt vmcnt(0)
    v_cmp_gt_u32 vcc, 8, v12
    s_cbranch_vccz LF_gos2
    s_sleep 2
    s_sub_u32 s30, s30, 1
    s_cmp_lg_u32 s30, 0
    s_cbranch_scc1 LF_spinls2
    s_branch LF_gos2
LF_spins2r:
    s_mov_b32 s30, 40000
LF_spinls2r:
    global_load_dword v12, v13, s[68:69] sc1
    s_waitcnt vmcnt(0)
    v_cmp_gt_u32 vcc, 8, v12
    s_cbranch_vccz LF_gos2r
    s_sleep 2
    s_sub_u32 s30, s30, 1
    s_cmp_lg_u32 s30, 0
    s_cbranch_scc1 LF_spinls2r
    s_branch LF_gos2r
LF_xredo:
    s_add_u32 s71, s71, 1
    s_waitcnt vmcnt(0) lgkmcnt(0)
    s_cmp_eq_u32 s21, 0
    s_cbranch_scc0 LF_xredo2
    s_and_b32 s26, s2, 7
    s_lshl_b32 s26, s26, 12
    s_add_u32 s26, s26, 163840
    v_and_b32 v13, 31, v1
    v_lshl_add_u32 v13, v13, 7, s26
    global_load_dword v12, v13, s[68:69] sc1
    s_waitcnt vmcnt(0)
    v_cmp_gt_u32 vcc, 8, v12
    s_cbranch_vccnz LF_spins2r
LF_gos2r:
LF_xredo2:
    s_sleep 16
    s_barrier
    s_mov_b32 s28, 0
    buffer_load_dwordx4 a[0:3], v8, s[4:7], s28 offen offset:0 sc1
    buffer_load_dwordx4 a[4:7], v8, s[4:7], s28 offen offset:1024 sc1
    buffer_load_dwordx4 a[8:11], v8, s[4:7], s28 offen offset:2048 sc1
    buffer_load_dwordx4 a[12:15], v8, s[4:7], s28 offen offset:3072 sc1
    s_mov_b32 s28, 4096
    buffer_load_dwordx4 a[16:19], v8, s[4:7], s28 offen offset:0 sc1
    buffer_load_dwordx4 a[20:23], v8, s[4:7], s28 offen offset:1024 sc1
    buffer_load_dwordx4 a[24:27], v8, s[4:7], s28 offen offset:2048 sc1
    buffer_load_dwordx4 a[28:31], v8, s[4:7], s28 offen offset:3072 sc1
    s_mov_b32 s28, 8192
    buffer_load_dwordx4 a[32:35], v8, s[4:7], s28 offen offset:0 sc1
    buffer_load_dwordx4 a[36:39], v8, s[4:7], s28 offen offset:1024 sc1
    buffer_load_dwordx4 a[40:43], v8, s[4:7], s28 offen offset:2048 sc1
    buffer_load_dwordx4 a[44:47], v8, s[4:7], s28 offen offset:3072 sc1
    s_mov_b32 s28, 12288
    buffer_load_dwordx4 a[48:51], v8, s[4:7], s28 offen offset:0 sc1
    buffer_load_dwordx4 a[52:55], v8, s[4:7], s28 offen offset:1024 sc1
    buffer_load_dwordx4 a[56:59], v8, s[4:7], s28 offen offset:2048 sc1
    buffer_load_dwordx4 a[60:63], v8, s[4:7], s28 offen offset:3072 sc1
    s_mov_b32 s28, 16384
    buffer_load_dwordx4 a[64:67], v8, s[4:7], s28 offen offset:0 sc1
    buffer_load_dwordx4 a[68:71], v8, s[4:7], s28 offen offset:1024 sc1
    buffer_load_dwordx4 a[72:75], v8, s[4:7], s28 offen offset:2048 sc1
    buffer_load_dwordx4 a[76:79], v8, s[4:7], s28 offen offset:3072 sc1
    s_mov_b32 s28, 20480
    buffer_load_dwordx4 a[80:83], v8, s[4:7], s28 offen offset:0 sc1
    buffer_load_dwordx4 a[84:87], v8, s[4:7], s28 offen offset:1024 sc1
    buffer_load_dwordx4 a[88:91], v8, s[4:7], s28 offen offset:2048 sc1
    buffer_load_dwordx4 a[92:95], v8, s[4:7], s28 offen offset:3072 sc1
    s_mov_b32 s28, 24576
    buffer_load_dwordx4 a[96:99], v8, s[4:7], s28 offen offset:0 sc1
    buffer_load_dwordx4 a[100:103], v8, s[4:7], s28 offen offset:1024 sc1
    buffer_load_dwordx4 a[104:107], v8, s[4:7], s28 offen offset:2048 sc1
    buffer_load_dwordx4 a[108:111], v8, s[4:7], s28 offen offset:3072 sc1
    s_mov_b32 s28, 28672
    buffer_load_dwordx4 a[112:115], v8, s[4:7], s28 offen offset:0 sc1
    buffer_load_dwordx4 a[116:119], v8, s[4:7], s28 offen offset:1024 sc1
    buffer_load_dwordx4 a[120:123], v8, s[4:7], s28 offen offset:2048 sc1
    buffer_load_dwordx4 a[124:127], v8, s[4:7], s28 offen offset:3072 sc1
    s_mov_b32 s28, 32768
    buffer_load_dwordx4 a[128:131], v8, s[4:7], s28 offen offset:0 sc1
    buffer_load_dwordx4 a[132:135], v8, s[4:7], s28 offen offset:1024 sc1
    buffer_load_dwordx4 a[136:139], v8, s[4:7], s28 offen offset:2048 sc1
    buffer_load_dwordx4 a[140:143], v8, s[4:7], s28 offen offset:3072 sc1
    s_mov_b32 s28, 36864
    buffer_load_dwordx4 a[144:147], v8, s[4:7], s28 offen offset:0 sc1
    buffer_load_dwordx4 a[148:151], v8, s[4:7], s28 offen offset:1024 sc1
    buffer_load_dwordx4 a[152:155], v8, s[4:7], s28 offen offset:2048 sc1
    buffer_load_dwordx4 a[156:159], v8, s[4:7], s28 offen offset:3072 sc1
    s_mov_b32 s28, 53248
    buffer_load_dwordx4 a[216:219], v8, s[4:7], s28 offen offset:2048 sc1
    buffer_load_dwordx4 a[220:223], v8, s[4:7], s28 offen offset:3072 sc1
    s_mov_b32 s28, 57344
    buffer_load_dwordx4 a[224:227], v8, s[4:7], s28 offen offset:0 sc1
    buffer_load_dwordx4 a[228:231], v8, s[4:7], s28 offen offset:1024 sc1
    buffer_load_dwordx4 a[232:235], v8, s[4:7], s28 offen offset:2048 sc1
    buffer_load_dwordx4 a[236:239], v8, s[4:7], s28 offen offset:3072 sc1
    s_mov_b32 s28, 40960
    buffer_load_dwordx4 a[160:163], v8, s[4:7], s28 offen offset:0 sc1
    buffer_load_dwordx4 a[164:167], v8, s[4:7], s28 offen offset:1024 sc1
    buffer_load_dwordx4 a[168:171], v8, s[4:7], s28 offen offset:2048 sc1
    buffer_load_dwordx4 a[172:175], v8, s[4:7], s28 offen offset:3072 sc1
    s_mov_b32 s28, 45056
    buffer_load_dwordx4 a[176:179], v8, s[4:7], s28 offen offset:0 sc1
    buffer_load_dwordx4 a[180:183], v8, s[4:7], s28 offen offset:1024 sc1
    buffer_load_dwordx4 a[184:187], v8, s[4:7], s28 offen offset:2048 sc1
    buffer_load_dwordx4 a[188:191], v8, s[4:7], s28 offen offset:3072 sc1
    s_mov_b32 s28, 49152
    buffer_load_dwordx4 a[192:195], v8, s[4:7], s28 offen offset:0 sc1
    buffer_load_dwordx4 a[196:199], v8, s[4:7], s28 offen offset:1024 sc1
    buffer_load_dwordx4 a[200:203], v8, s[4:7], s28 offen offset:2048 sc1
    buffer_load_dwordx4 a[204:207], v8, s[4:7], s28 offen offset:3072 sc1
    s_mov_b32 s28, 53248
    buffer_load_dwordx4 a[208:211], v8, s[4:7], s28 offen offset:0 sc1
    buffer_load_dwordx4 a[212:215], v8, s[4:7], s28 offen offset:1024 sc1
    v_subrev_u32 v3, 2490368, v3
    s_lshl_b32 s26, s21, 10
    s_mov_b32 m0, s26
    s_waitcnt vmcnt(0)
    s_branch LF_x1
LF_spinh1:
    s_mov_b32 s30, 40000
LF_spinlh1:
    global_load_dword v12, v11, s[68:69] sc1
    s_waitcnt vmcnt(0)
    v_cmp_gt_u32 vcc, 1, v12
    s_cbranch_vccz LF_goh1
    s_sleep 2
    s_sub_u32 s30, s30, 1
    s_cmp_lg_u32 s30, 0
    s_cbranch_scc1 LF_spinlh1
    s_branch LF_goh1
LF_g2redo:
    s_add_u32 s92, s92, 1
    s_waitcnt vmcnt(0) lgkmcnt(0)
    s_sleep 16
    v_add_u32 v4, s80, v8
    v_add_u32 v5, s81, v8
    v_add_u32 v6, s82, v8
    v_add_u32 v7, s83, v8
    s_add_u32 s79, s78, 0
    buffer_load_dwordx4 v[104:107], v4, s[12:15], s79 offen sc1
    buffer_load_dwordx4 v[108:111], v5, s[12:15], s79 offen sc1
    buffer_load_dwordx4 v[112:115], v6, s[12:15], s79 offen sc1
    buffer_load_dwordx4 v[116:119], v7, s[12:15], s79 offen sc1
    s_add_u32 s79, s78, 8192
    buffer_load_dwordx4 v[120:123], v4, s[12:15], s79 offen sc1
    buffer_load_dwordx4 v[124:127], v5, s[12:15], s79 offen sc1
    buffer_load_dwordx4 v[128:131], v6, s[12:15], s79 offen sc1
    buffer_load_dwordx4 v[132:135], v7, s[12:15], s79 offen sc1
    s_add_u32 s79, s78, 12288
    buffer_load_dwordx4 v[136:139], v4, s[12:15], s79 offen sc1
    buffer_load_dwordx4 v[140:143], v5, s[12:15], s79 offen sc1
    buffer_load_dwordx4 v[144:147], v6, s[12:15], s79 offen sc1
    buffer_load_dwordx4 v[148:151], v7, s[12:15], s79 offen sc1
    s_add_u32 s79, s78, 20480
    buffer_load_dwordx4 v[152:155], v4, s[12:15], s79 offen sc1
    buffer_load_dwordx4 v[156:159], v5, s[12:15], s79 offen sc1
    buffer_load_dwordx4 v[160:163], v6, s[12:15], s79 offen sc1
    buffer_load_dwordx4 v[164:167], v7, s[12:15], s79 offen sc1
    s_waitcnt vmcnt(0)
    s_branch LF_g2
LF_spinh2:
    s_mov_b32 s30, 40000
LF_spinlh2:
    global_load_dword v12, v11, s[68:69] sc1
    s_waitcnt vmcnt(0)
    v_cmp_gt_u32 vcc, 2, v12
    s_cbranch_vccz LF_goh2
    s_sleep 2
    s_sub_u32 s30, s30, 1
    s_cmp_lg_u32 s30, 0
    s_cbranch_scc1 LF_spinlh2
    s_branch LF_goh2
LF_codeend:
.section .rodata,"a"
.p2align 6
.amdhsa_kernel adaLN_cond__ssm_conv_s4__dense_activation_silu__prompt_kernel
  .amdhsa_next_free_vgpr 512
  .amdhsa_next_free_sgpr 100
  .amdhsa_accum_offset 256
  .amdhsa_group_segment_fixed_size 0
  .amdhsa_kernarg_size 136
  .amdhsa_user_sgpr_count 2
  .amdhsa_user_sgpr_kernarg_segment_ptr 1
  .amdhsa_system_sgpr_workgroup_id_x 1
.end_amdhsa_kernel
```
